```python
import torch

def _softmax(x, axis=-1):
    return torch.softmax(x, dim=axis)
def _gelu(x):
    return torch.nn.functional.gelu(x, approximate="tanh")
def _silu(x):
    return torch.nn.functional.silu(x)
def _sigmoid(x):
    return torch.sigmoid(x)
def _layernorm(x, axis=-1, eps=1e-5):
    m = x.mean(dim=axis, keepdim=True)
    v = x.var(dim=axis, keepdim=True, unbiased=False)
    return (x - m) / torch.sqrt(v + eps)
def _scatter_add(tgt, idx, src, axis=0):
    return tgt.clone().index_add_(axis, idx, src)
def _segment_sum(src, seg, n):
    out = torch.zeros((n,) + src.shape[1:], dtype=src.dtype)
    return out.index_add_(0, seg, src)
def _pad(x, pw):
    flat = tuple(v for pair in reversed(pw) for v in pair)
    return torch.nn.functional.pad(x, flat)

kernel_name = 'standalone__mha_softmax__near_ridge'

def setup_inputs():

    _w = (lambda a: (lambda t: t.to(torch.bfloat16) if t.is_floating_point() else t)(torch.as_tensor(a)))
    B, H, Sq, Sk, D = 8, 32, 384, 2048, 128
    return {
        "q": _w((lambda *s: torch.randn(*s, dtype=torch.bfloat16) * 0.8)(B, H, Sq, D)),
        "k": _w((lambda *s: torch.randn(*s, dtype=torch.bfloat16) * 0.8)(B, H, Sk, D)),
        "v": _w((lambda *s: torch.randn(*s, dtype=torch.bfloat16) * 0.05)(B, H, Sk, D)),
    }

def reference(q, k, v):
    scale = q.shape[-1] ** -0.5
    scores = torch.einsum("bhqd,bhkd->bhqk", q, k) * scale
    p = _softmax(scores, axis=-1)
    return torch.einsum("bhqk,bhkd->bhqd", p, v)
```

```asm
; @launch grid=(256,1,1) block=(256,1,1) lds=163840
.amdgcn_target "amdgcn-amd-amdhsa--gfx950"
.text
.globl standalone__mha_softmax__near_ridge_kernel
.p2align 8
.type standalone__mha_softmax__near_ridge_kernel,@function
standalone__mha_softmax__near_ridge_kernel:
    s_cmp_ge_u32 s2, 256
    s_cbranch_scc1 L_end
    s_load_dwordx4 s[4:7], s[0:1], 0
    s_load_dwordx4 s[8:11], s[0:1], 16
    v_lshrrev_b32 v2, 6, v0
    v_and_b32 v1, 63, v0
    v_and_b32 v3, 15, v1
    v_readfirstlane_b32 s32, v2
    v_lshrrev_b32 v4, 4, v1
    v_lshlrev_b32 v5, 8, v3
    v_lshl_add_u32 v216, v4, 4, v5
    v_lshlrev_b32 v8, 8, v4
    s_mul_i32 s76, s32, 3
    s_lshl_b32 s77, s32, 1
    s_add_u32 s46, s76, 0
    s_and_b32 s46, s46, 3
    s_lshl_b32 s46, s46, 2
    v_or_b32 v6, s46, v4
    v_xor_b32 v6, v6, v3
    v_lshl_add_u32 v250, v6, 4, v8
    s_add_u32 s46, s76, 1
    s_and_b32 s46, s46, 3
    s_lshl_b32 s46, s46, 2
    v_or_b32 v6, s46, v4
    v_xor_b32 v6, v6, v3
    v_lshl_add_u32 v251, v6, 4, v8
    s_add_u32 s46, s76, 2
    s_and_b32 s46, s46, 3
    s_lshl_b32 s46, s46, 2
    v_or_b32 v6, s46, v4
    v_xor_b32 v6, v6, v3
    v_lshl_add_u32 v252, v6, 4, v8
    s_add_u32 s46, s77, 0
    s_and_b32 s46, s46, 3
    s_lshl_b32 s46, s46, 2
    v_or_b32 v6, s46, v4
    v_xor_b32 v6, v6, v3
    v_lshl_add_u32 v253, v6, 4, v8
    s_add_u32 s46, s77, 1
    s_and_b32 s46, s46, 3
    s_lshl_b32 s46, s46, 2
    v_or_b32 v6, s46, v4
    v_xor_b32 v6, v6, v3
    v_lshl_add_u32 v254, v6, 4, v8
    v_or_b32 v6, 0, v4
    v_xor_b32 v6, v6, v3
    v_lshl_add_u32 v210, v6, 4, v8
    v_or_b32 v6, 4, v4
    v_xor_b32 v6, v6, v3
    v_lshl_add_u32 v211, v6, 4, v8
    v_or_b32 v6, 8, v4
    v_xor_b32 v6, v6, v3
    v_lshl_add_u32 v212, v6, 4, v8
    v_or_b32 v6, 12, v4
    v_xor_b32 v6, v6, v3
    v_lshl_add_u32 v213, v6, 4, v8
    s_mov_b32 s78, 32768
    s_cmp_eq_u32 s32, 1
    s_cselect_b32 s78, 98304, s78
    s_cmp_eq_u32 s32, 2
    s_cselect_b32 s78, 118784, s78
    s_cmp_eq_u32 s32, 3
    s_cselect_b32 s78, 139264, s78
    s_lshl_b32 s76, s76, 10
    s_lshl_b32 s77, s77, 10
    s_lshl_b32 s34, s32, 12
    s_add_u32 s35, s34, 65536
    s_mul_i32 s33, s2, 98304
    s_mul_i32 s36, s32, 24576
    s_add_u32 s33, s33, s36
    s_lshl_b32 s46, s2, 19
    s_mov_b32 s41, 4096
    s_mov_b32 s42, 8192
    s_mov_b32 s43, 12288
    s_mov_b32 s44, 16384
    s_mov_b32 s45, 20480
    s_waitcnt lgkmcnt(0)
    s_add_u32 s16, s6, s46
    s_addc_u32 s17, s7, 0
    s_and_b32 s17, s17, 0xffff
    s_mov_b32 s18, 524288
    s_mov_b32 s19, 0x20000
    s_add_u32 m0, s76, 53248
    s_nop 0
    buffer_load_dwordx4 v250, s[16:19], s76 offen nt lds
    buffer_load_dwordx4 v251, s[16:19], s76 offen offset:1024 nt lds
    buffer_load_dwordx4 v252, s[16:19], s76 offen offset:2048 nt lds
    s_add_u32 s12, s4, s33
    s_addc_u32 s13, s5, 0
    s_and_b32 s13, s13, 0xffff
    s_mov_b32 s14, 24576
    s_mov_b32 s15, 0x20000
    s_add_u32 m0, s78, 0
    s_nop 0
    buffer_load_dwordx4 v210, s[12:15], 0 offen nt lds
    buffer_load_dwordx4 v211, s[12:15], 0 offen offset:1024 nt lds
    buffer_load_dwordx4 v212, s[12:15], 0 offen offset:2048 nt lds
    buffer_load_dwordx4 v213, s[12:15], 0 offen offset:3072 nt lds
    s_getreg_b32 s79, hwreg(HW_REG_XCC_ID, 0, 4)
    s_and_b32 s79, s79, 1
    s_cmp_eq_u32 s79, 0
    s_cbranch_scc1 L_pro_b
    s_add_u32 m0, s78, 4096
    s_nop 0
    buffer_load_dwordx4 v210, s[12:15], s41 offen nt lds
    buffer_load_dwordx4 v211, s[12:15], s41 offen offset:1024 nt lds
    buffer_load_dwordx4 v212, s[12:15], s41 offen offset:2048 nt lds
    buffer_load_dwordx4 v213, s[12:15], s41 offen offset:3072 nt lds
    s_add_u32 m0, s78, 8192
    s_nop 0
    buffer_load_dwordx4 v210, s[12:15], s42 offen nt lds
    buffer_load_dwordx4 v211, s[12:15], s42 offen offset:1024 nt lds
    buffer_load_dwordx4 v212, s[12:15], s42 offen offset:2048 nt lds
    buffer_load_dwordx4 v213, s[12:15], s42 offen offset:3072 nt lds
    s_add_u32 m0, s78, 12288
    s_nop 0
    buffer_load_dwordx4 v210, s[12:15], s43 offen nt lds
    buffer_load_dwordx4 v211, s[12:15], s43 offen offset:1024 nt lds
    buffer_load_dwordx4 v212, s[12:15], s43 offen offset:2048 nt lds
    buffer_load_dwordx4 v213, s[12:15], s43 offen offset:3072 nt lds
    s_getpc_b64 s[72:73]
L_pc_a:
    v_lshlrev_b32 v6, 7, v1
    s_lshl_b32 s74, s32, 13
    v_add_u32 v6, s74, v6
    s_mov_b32 s75, L_pro_b-L_pc_a-4
    v_min_u32 v6, s75, v6
    global_load_dword v9, v6, s[72:73]
    s_add_u32 s28, s10, s33
    s_addc_u32 s29, s11, 0
    s_and_b32 s29, s29, 0xffff
    s_mov_b32 s30, 24576
    s_mov_b32 s31, 0x20000
    s_add_u32 s20, s16, 12288
    s_addc_u32 s21, s17, 0
    s_and_b32 s21, s21, 0xffff
    s_mov_b32 s22, 512000
    s_mov_b32 s23, 0x20000
    s_add_u32 s24, s8, s46
    s_addc_u32 s25, s9, 0
    s_and_b32 s25, s25, 0xffff
    s_mov_b32 s26, 524288
    s_mov_b32 s27, 0x20000
    s_add_u32 s88, s34, 0
    s_add_u32 s92, s35, 0
    s_add_u32 s89, s34, 16384
    s_add_u32 s93, s35, 16384
    s_add_u32 s90, s34, 32768
    s_add_u32 s94, s35, 32768
    s_add_u32 s91, s34, 49152
    s_add_u32 s95, s35, 49152
    s_mov_b32 s37, 0
    s_mov_b32 s38, 0x3e0293ee
    s_mov_b32 s50, 0x7b800000
    v_or_b32 v6, 0, v4
    v_lshlrev_b32 v6, 1, v6
    v_xor_b32 v6, v6, v3
    v_lshl_add_u32 v214, v6, 4, v8
    v_or_b32 v6, 4, v4
    v_lshlrev_b32 v6, 1, v6
    v_xor_b32 v6, v6, v3
    v_lshl_add_u32 v215, v6, 4, v8
    v_and_b32 v6, 1, v4
    v_lshl_add_u32 v6, v6, 5, v5
    v_lshrrev_b32 v7, 1, v4
    v_lshl_add_u32 v217, v7, 4, v6
    v_or_b32 v6, 0, v4
    v_xor_b32 v6, v6, v3
    v_lshl_add_u32 v198, v6, 4, v5
    v_or_b32 v6, 4, v4
    v_xor_b32 v6, v6, v3
    v_lshl_add_u32 v199, v6, 4, v5
    v_or_b32 v6, 8, v4
    v_xor_b32 v6, v6, v3
    v_lshl_add_u32 v200, v6, 4, v5
    v_or_b32 v6, 12, v4
    v_xor_b32 v6, v6, v3
    v_lshl_add_u32 v201, v6, 4, v5
    v_add_u32 v10, s78, v198
    v_add_u32 v11, s78, v199
    v_add_u32 v12, s78, v200
    v_add_u32 v13, s78, v201
    v_lshrrev_b32 v6, 2, v3
    v_lshl_add_u32 v6, v4, 2, v6
    v_and_b32 v7, 7, v6
    v_lshlrev_b32 v6, 8, v6
    v_and_b32 v8, 3, v3
    v_lshl_add_u32 v6, v8, 3, v6
    v_add_u32 v6, 65536, v6
    v_xor_b32 v8, 0, v7
    v_lshl_add_u32 v202, v8, 5, v6
    v_xor_b32 v8, 1, v7
    v_lshl_add_u32 v203, v8, 5, v6
    v_xor_b32 v8, 2, v7
    v_lshl_add_u32 v204, v8, 5, v6
    v_xor_b32 v8, 3, v7
    v_lshl_add_u32 v205, v8, 5, v6
    v_xor_b32 v8, 4, v7
    v_lshl_add_u32 v206, v8, 5, v6
    v_xor_b32 v8, 5, v7
    v_lshl_add_u32 v207, v8, 5, v6
    v_xor_b32 v8, 6, v7
    v_lshl_add_u32 v208, v8, 5, v6
    v_xor_b32 v8, 7, v7
    v_lshl_add_u32 v209, v8, 5, v6
    v_mov_b32 v192, 0
    v_mov_b32 v193, 0
    v_mov_b32 v194, 0
    v_mov_b32 v195, 0
    v_mov_b32 v196, 0
    v_mov_b32 v197, 0
    s_add_u32 s46, s34, 32768
    v_and_b32 v226, 63, v0
    v_and_b32 v227, 15, v226
    v_lshrrev_b32 v228, 4, v226
    v_and_b32 v229, 1, v228
    v_lshlrev_b32 v229, 3, v229
    v_lshl_add_u32 v229, v227, 8, v229
    v_add_u32 v229, s46, v229
    v_lshrrev_b32 v228, 1, v228
    v_or_b32 v230, 0, v228
    v_xor_b32 v230, v230, v227
    v_lshl_add_u32 v1, v230, 4, v229
    v_or_b32 v230, 2, v228
    v_xor_b32 v230, v230, v227
    v_lshl_add_u32 v2, v230, 4, v229
    v_or_b32 v230, 4, v228
    v_xor_b32 v230, v230, v227
    v_lshl_add_u32 v3, v230, 4, v229
    v_or_b32 v230, 6, v228
    v_xor_b32 v230, v230, v227
    v_lshl_add_u32 v4, v230, 4, v229
    v_or_b32 v230, 8, v228
    v_xor_b32 v230, v230, v227
    v_lshl_add_u32 v5, v230, 4, v229
    v_or_b32 v230, 10, v228
    v_xor_b32 v230, v230, v227
    v_lshl_add_u32 v6, v230, 4, v229
    v_or_b32 v230, 12, v228
    v_xor_b32 v230, v230, v227
    v_lshl_add_u32 v7, v230, 4, v229
    v_or_b32 v230, 14, v228
    v_xor_b32 v230, v230, v227
    v_lshl_add_u32 v8, v230, 4, v229
    s_waitcnt vmcnt(17)
    s_barrier
    ds_read_b128 a[240:243], v198 offset:53248
    ds_read_b128 a[244:247], v199 offset:53248
    ds_read_b128 a[248:251], v200 offset:53248
    ds_read_b128 a[252:255], v201 offset:53248
    ds_read_b128 a[208:211], v198 offset:57344
    ds_read_b128 a[212:215], v199 offset:57344
    ds_read_b128 a[216:219], v200 offset:57344
    ds_read_b128 a[220:223], v201 offset:57344
    ds_read_b128 a[192:195], v198 offset:61440
    ds_read_b128 a[196:199], v199 offset:61440
    ds_read_b128 a[200:203], v200 offset:61440
    ds_read_b128 a[204:207], v201 offset:61440
    s_waitcnt vmcnt(13)
    ds_read_b128 v[160:163], v10
    ds_read_b128 v[164:167], v11
    ds_read_b128 v[168:171], v12
    ds_read_b128 v[172:175], v13
    s_add_u32 m0, s78, 16384
    s_nop 0
    buffer_load_dwordx4 v210, s[12:15], s44 offen nt lds
    buffer_load_dwordx4 v211, s[12:15], s44 offen offset:1024 nt lds
    buffer_load_dwordx4 v212, s[12:15], s44 offen offset:2048 nt lds
    buffer_load_dwordx4 v213, s[12:15], s44 offen offset:3072 nt lds
    s_waitcnt lgkmcnt(0)
    v_lshlrev_b32 v218, 16, v160
    v_and_b32 v219, 0xffff0000, v160
    v_lshlrev_b32 v220, 16, v161
    v_and_b32 v221, 0xffff0000, v161
    v_mul_f32 v218, s38, v218
    v_mul_f32 v219, s38, v219
    v_mul_f32 v220, s38, v220
    v_mul_f32 v221, s38, v221
    v_cvt_pk_bf16_f32 v218, v218, v219
    v_cvt_pk_bf16_f32 v220, v220, v221
    v_accvgpr_write_b32 a96, v218
    v_accvgpr_write_b32 a97, v220
    v_lshlrev_b32 v218, 16, v162
    v_and_b32 v219, 0xffff0000, v162
    v_lshlrev_b32 v220, 16, v163
    v_and_b32 v221, 0xffff0000, v163
    v_mul_f32 v218, s38, v218
    v_mul_f32 v219, s38, v219
    v_mul_f32 v220, s38, v220
    v_mul_f32 v221, s38, v221
    v_cvt_pk_bf16_f32 v218, v218, v219
    v_cvt_pk_bf16_f32 v220, v220, v221
    v_accvgpr_write_b32 a98, v218
    v_accvgpr_write_b32 a99, v220
    v_lshlrev_b32 v218, 16, v164
    v_and_b32 v219, 0xffff0000, v164
    v_lshlrev_b32 v220, 16, v165
    v_and_b32 v221, 0xffff0000, v165
    v_mul_f32 v218, s38, v218
    v_mul_f32 v219, s38, v219
    v_mul_f32 v220, s38, v220
    v_mul_f32 v221, s38, v221
    v_cvt_pk_bf16_f32 v218, v218, v219
    v_cvt_pk_bf16_f32 v220, v220, v221
    v_accvgpr_write_b32 a100, v218
    v_accvgpr_write_b32 a101, v220
    v_lshlrev_b32 v218, 16, v166
    v_and_b32 v219, 0xffff0000, v166
    v_lshlrev_b32 v220, 16, v167
    v_and_b32 v221, 0xffff0000, v167
    v_mul_f32 v218, s38, v218
    v_mul_f32 v219, s38, v219
    v_mul_f32 v220, s38, v220
    v_mul_f32 v221, s38, v221
    v_cvt_pk_bf16_f32 v218, v218, v219
    v_cvt_pk_bf16_f32 v220, v220, v221
    v_accvgpr_write_b32 a102, v218
    v_accvgpr_write_b32 a103, v220
    v_lshlrev_b32 v218, 16, v168
    v_and_b32 v219, 0xffff0000, v168
    v_lshlrev_b32 v220, 16, v169
    v_and_b32 v221, 0xffff0000, v169
    v_mul_f32 v218, s38, v218
    v_mul_f32 v219, s38, v219
    v_mul_f32 v220, s38, v220
    v_mul_f32 v221, s38, v221
    v_cvt_pk_bf16_f32 v218, v218, v219
    v_cvt_pk_bf16_f32 v220, v220, v221
    v_accvgpr_write_b32 a104, v218
    v_accvgpr_write_b32 a105, v220
    v_lshlrev_b32 v218, 16, v170
    v_and_b32 v219, 0xffff0000, v170
    v_lshlrev_b32 v220, 16, v171
    v_and_b32 v221, 0xffff0000, v171
    v_mul_f32 v218, s38, v218
    v_mul_f32 v219, s38, v219
    v_mul_f32 v220, s38, v220
    v_mul_f32 v221, s38, v221
    v_cvt_pk_bf16_f32 v218, v218, v219
    v_cvt_pk_bf16_f32 v220, v220, v221
    v_accvgpr_write_b32 a106, v218
    v_accvgpr_write_b32 a107, v220
    v_lshlrev_b32 v218, 16, v172
    v_and_b32 v219, 0xffff0000, v172
    v_lshlrev_b32 v220, 16, v173
    v_and_b32 v221, 0xffff0000, v173
    v_mul_f32 v218, s38, v218
    v_mul_f32 v219, s38, v219
    v_mul_f32 v220, s38, v220
    v_mul_f32 v221, s38, v221
    v_cvt_pk_bf16_f32 v218, v218, v219
    v_cvt_pk_bf16_f32 v220, v220, v221
    v_accvgpr_write_b32 a108, v218
    v_accvgpr_write_b32 a109, v220
    v_lshlrev_b32 v218, 16, v174
    v_and_b32 v219, 0xffff0000, v174
    v_lshlrev_b32 v220, 16, v175
    v_and_b32 v221, 0xffff0000, v175
    v_mul_f32 v218, s38, v218
    v_mul_f32 v219, s38, v219
    v_mul_f32 v220, s38, v220
    v_mul_f32 v221, s38, v221
    v_cvt_pk_bf16_f32 v218, v218, v219
    v_cvt_pk_bf16_f32 v220, v220, v221
    v_accvgpr_write_b32 a110, v218
    v_accvgpr_write_b32 a111, v220
    s_waitcnt lgkmcnt(0)
    v_mfma_f32_16x16x32_bf16 v[184:187], a[240:243], a[96:99], 0
    v_mfma_f32_16x16x32_bf16 v[184:187], a[244:247], a[100:103], v[184:187]
    v_mfma_f32_16x16x32_bf16 v[184:187], a[248:251], a[104:107], v[184:187]
    v_mfma_f32_16x16x32_bf16 v[184:187], a[252:255], a[108:111], v[184:187]
    s_nop 7
    v_max3_f32 v222, v184, v185, v186
    v_max_f32 v222, v222, v187
    v_mov_b32 v223, v222
    s_nop 1
    v_permlane32_swap_b32 v222, v223
    v_max_f32 v222, v222, v223
    v_mov_b32 v223, v222
    s_nop 1
    v_permlane16_swap_b32 v222, v223
    v_max_f32 v222, v222, v223
    v_sub_f32 v112, 0, v222
    v_sub_f32 v113, 0, v222
    v_sub_f32 v114, 0, v222
    v_sub_f32 v115, 0, v222
    v_add_f32 v184, v184, v112
    v_add_f32 v185, v185, v112
    v_add_f32 v186, v186, v112
    v_add_f32 v187, v187, v112
    v_mfma_f32_16x16x32_bf16 v[188:191], a[208:211], a[96:99], v[112:115]
    v_mfma_f32_16x16x32_bf16 v[188:191], a[212:215], a[100:103], v[188:191]
    v_mfma_f32_16x16x32_bf16 v[188:191], a[216:219], a[104:107], v[188:191]
    v_mfma_f32_16x16x32_bf16 v[188:191], a[220:223], a[108:111], v[188:191]
    v_exp_f32 v184, v184
    v_exp_f32 v185, v185
    v_exp_f32 v186, v186
    v_exp_f32 v187, v187
    v_add_f32 v192, v192, v184
    v_add_f32 v192, v192, v185
    v_add_f32 v192, v192, v186
    v_add_f32 v192, v192, v187
    v_cvt_pk_bf16_f32 v136, v184, v185
    v_cvt_pk_bf16_f32 v137, v186, v187
    v_exp_f32 v188, v188
    v_exp_f32 v189, v189
    v_exp_f32 v190, v190
    v_exp_f32 v191, v191
    v_add_f32 v192, v192, v188
    v_add_f32 v192, v192, v189
    v_add_f32 v192, v192, v190
    v_add_f32 v192, v192, v191
    v_cvt_pk_bf16_f32 v138, v188, v189
    v_cvt_pk_bf16_f32 v139, v190, v191
    s_waitcnt vmcnt(13)
    ds_read_b128 v[160:163], v10 offset:4096
    ds_read_b128 v[164:167], v11 offset:4096
    ds_read_b128 v[168:171], v12 offset:4096
    ds_read_b128 v[172:175], v13 offset:4096
    s_add_u32 m0, s78, 0
    s_nop 0
    buffer_load_dwordx4 v210, s[12:15], s45 offen nt lds
    buffer_load_dwordx4 v211, s[12:15], s45 offen offset:1024 nt lds
    buffer_load_dwordx4 v212, s[12:15], s45 offen offset:2048 nt lds
    buffer_load_dwordx4 v213, s[12:15], s45 offen offset:3072 nt lds
    s_waitcnt lgkmcnt(0)
    v_lshlrev_b32 v218, 16, v160
    v_and_b32 v219, 0xffff0000, v160
    v_lshlrev_b32 v220, 16, v161
    v_and_b32 v221, 0xffff0000, v161
    v_mul_f32 v218, s38, v218
    v_mul_f32 v219, s38, v219
    v_mul_f32 v220, s38, v220
    v_mul_f32 v221, s38, v221
    v_cvt_pk_bf16_f32 v218, v218, v219
    v_cvt_pk_bf16_f32 v220, v220, v221
    v_accvgpr_write_b32 a112, v218
    v_accvgpr_write_b32 a113, v220
    v_lshlrev_b32 v218, 16, v162
    v_and_b32 v219, 0xffff0000, v162
    v_lshlrev_b32 v220, 16, v163
    v_and_b32 v221, 0xffff0000, v163
    v_mul_f32 v218, s38, v218
    v_mul_f32 v219, s38, v219
    v_mul_f32 v220, s38, v220
    v_mul_f32 v221, s38, v221
    v_cvt_pk_bf16_f32 v218, v218, v219
    v_cvt_pk_bf16_f32 v220, v220, v221
    v_accvgpr_write_b32 a114, v218
    v_accvgpr_write_b32 a115, v220
    v_lshlrev_b32 v218, 16, v164
    v_and_b32 v219, 0xffff0000, v164
    v_lshlrev_b32 v220, 16, v165
    v_and_b32 v221, 0xffff0000, v165
    v_mul_f32 v218, s38, v218
    v_mul_f32 v219, s38, v219
    v_mul_f32 v220, s38, v220
    v_mul_f32 v221, s38, v221
    v_cvt_pk_bf16_f32 v218, v218, v219
    v_cvt_pk_bf16_f32 v220, v220, v221
    v_accvgpr_write_b32 a116, v218
    v_accvgpr_write_b32 a117, v220
    v_lshlrev_b32 v218, 16, v166
    v_and_b32 v219, 0xffff0000, v166
    v_lshlrev_b32 v220, 16, v167
    v_and_b32 v221, 0xffff0000, v167
    v_mul_f32 v218, s38, v218
    v_mul_f32 v219, s38, v219
    v_mul_f32 v220, s38, v220
    v_mul_f32 v221, s38, v221
    v_cvt_pk_bf16_f32 v218, v218, v219
    v_cvt_pk_bf16_f32 v220, v220, v221
    v_accvgpr_write_b32 a118, v218
    v_accvgpr_write_b32 a119, v220
    v_lshlrev_b32 v218, 16, v168
    v_and_b32 v219, 0xffff0000, v168
    v_lshlrev_b32 v220, 16, v169
    v_and_b32 v221, 0xffff0000, v169
    v_mul_f32 v218, s38, v218
    v_mul_f32 v219, s38, v219
    v_mul_f32 v220, s38, v220
    v_mul_f32 v221, s38, v221
    v_cvt_pk_bf16_f32 v218, v218, v219
    v_cvt_pk_bf16_f32 v220, v220, v221
    v_accvgpr_write_b32 a120, v218
    v_accvgpr_write_b32 a121, v220
    v_lshlrev_b32 v218, 16, v170
    v_and_b32 v219, 0xffff0000, v170
    v_lshlrev_b32 v220, 16, v171
    v_and_b32 v221, 0xffff0000, v171
    v_mul_f32 v218, s38, v218
    v_mul_f32 v219, s38, v219
    v_mul_f32 v220, s38, v220
    v_mul_f32 v221, s38, v221
    v_cvt_pk_bf16_f32 v218, v218, v219
    v_cvt_pk_bf16_f32 v220, v220, v221
    v_accvgpr_write_b32 a122, v218
    v_accvgpr_write_b32 a123, v220
    v_lshlrev_b32 v218, 16, v172
    v_and_b32 v219, 0xffff0000, v172
    v_lshlrev_b32 v220, 16, v173
    v_and_b32 v221, 0xffff0000, v173
    v_mul_f32 v218, s38, v218
    v_mul_f32 v219, s38, v219
    v_mul_f32 v220, s38, v220
    v_mul_f32 v221, s38, v221
    v_cvt_pk_bf16_f32 v218, v218, v219
    v_cvt_pk_bf16_f32 v220, v220, v221
    v_accvgpr_write_b32 a124, v218
    v_accvgpr_write_b32 a125, v220
    v_lshlrev_b32 v218, 16, v174
    v_and_b32 v219, 0xffff0000, v174
    v_lshlrev_b32 v220, 16, v175
    v_and_b32 v221, 0xffff0000, v175
    v_mul_f32 v218, s38, v218
    v_mul_f32 v219, s38, v219
    v_mul_f32 v220, s38, v220
    v_mul_f32 v221, s38, v221
    v_cvt_pk_bf16_f32 v218, v218, v219
    v_cvt_pk_bf16_f32 v220, v220, v221
    v_accvgpr_write_b32 a126, v218
    v_accvgpr_write_b32 a127, v220
    v_mfma_f32_16x16x32_bf16 v[184:187], a[240:243], a[112:115], 0
    v_mfma_f32_16x16x32_bf16 v[184:187], a[244:247], a[116:119], v[184:187]
    v_mfma_f32_16x16x32_bf16 v[184:187], a[248:251], a[120:123], v[184:187]
    v_mfma_f32_16x16x32_bf16 v[184:187], a[252:255], a[124:127], v[184:187]
    s_nop 7
    v_max3_f32 v222, v184, v185, v186
    v_max_f32 v222, v222, v187
    v_mov_b32 v223, v222
    s_nop 1
    v_permlane32_swap_b32 v222, v223
    v_max_f32 v222, v222, v223
    v_mov_b32 v223, v222
    s_nop 1
    v_permlane16_swap_b32 v222, v223
    v_max_f32 v222, v222, v223
    v_sub_f32 v116, 0, v222
    v_sub_f32 v117, 0, v222
    v_sub_f32 v118, 0, v222
    v_sub_f32 v119, 0, v222
    v_add_f32 v184, v184, v116
    v_add_f32 v185, v185, v116
    v_add_f32 v186, v186, v116
    v_add_f32 v187, v187, v116
    v_mfma_f32_16x16x32_bf16 v[188:191], a[208:211], a[112:115], v[116:119]
    v_mfma_f32_16x16x32_bf16 v[188:191], a[212:215], a[116:119], v[188:191]
    v_mfma_f32_16x16x32_bf16 v[188:191], a[216:219], a[120:123], v[188:191]
    v_mfma_f32_16x16x32_bf16 v[188:191], a[220:223], a[124:127], v[188:191]
    v_exp_f32 v184, v184
    v_exp_f32 v185, v185
    v_exp_f32 v186, v186
    v_exp_f32 v187, v187
    v_add_f32 v193, v193, v184
    v_add_f32 v193, v193, v185
    v_add_f32 v193, v193, v186
    v_add_f32 v193, v193, v187
    v_cvt_pk_bf16_f32 v140, v184, v185
    v_cvt_pk_bf16_f32 v141, v186, v187
    v_exp_f32 v188, v188
    v_exp_f32 v189, v189
    v_exp_f32 v190, v190
    v_exp_f32 v191, v191
    v_add_f32 v193, v193, v188
    v_add_f32 v193, v193, v189
    v_add_f32 v193, v193, v190
    v_add_f32 v193, v193, v191
    v_cvt_pk_bf16_f32 v142, v188, v189
    v_cvt_pk_bf16_f32 v143, v190, v191
    s_waitcnt vmcnt(13)
    ds_read_b128 v[160:163], v10 offset:8192
    ds_read_b128 v[164:167], v11 offset:8192
    ds_read_b128 v[168:171], v12 offset:8192
    ds_read_b128 v[172:175], v13 offset:8192
    s_mov_b32 m0, s77
    s_nop 0
    buffer_load_dwordx4 v253, s[20:23], s77 offen nt lds
    buffer_load_dwordx4 v254, s[20:23], s77 offen offset:1024 nt lds
    s_add_u32 m0, s77, 65536
    s_nop 0
    buffer_load_dwordx4 v214, s[24:27], s77 offen nt lds
    buffer_load_dwordx4 v215, s[24:27], s77 offen offset:1024 nt lds
    s_waitcnt lgkmcnt(0)
    v_lshlrev_b32 v218, 16, v160
    v_and_b32 v219, 0xffff0000, v160
    v_lshlrev_b32 v220, 16, v161
    v_and_b32 v221, 0xffff0000, v161
    v_mul_f32 v218, s38, v218
    v_mul_f32 v219, s38, v219
    v_mul_f32 v220, s38, v220
    v_mul_f32 v221, s38, v221
    v_cvt_pk_bf16_f32 v218, v218, v219
    v_cvt_pk_bf16_f32 v220, v220, v221
    v_accvgpr_write_b32 a128, v218
    v_accvgpr_write_b32 a129, v220
    v_lshlrev_b32 v218, 16, v162
    v_and_b32 v219, 0xffff0000, v162
    v_lshlrev_b32 v220, 16, v163
    v_and_b32 v221, 0xffff0000, v163
    v_mul_f32 v218, s38, v218
    v_mul_f32 v219, s38, v219
    v_mul_f32 v220, s38, v220
    v_mul_f32 v221, s38, v221
    v_cvt_pk_bf16_f32 v218, v218, v219
    v_cvt_pk_bf16_f32 v220, v220, v221
    v_accvgpr_write_b32 a130, v218
    v_accvgpr_write_b32 a131, v220
    v_lshlrev_b32 v218, 16, v164
    v_and_b32 v219, 0xffff0000, v164
    v_lshlrev_b32 v220, 16, v165
    v_and_b32 v221, 0xffff0000, v165
    v_mul_f32 v218, s38, v218
    v_mul_f32 v219, s38, v219
    v_mul_f32 v220, s38, v220
    v_mul_f32 v221, s38, v221
    v_cvt_pk_bf16_f32 v218, v218, v219
    v_cvt_pk_bf16_f32 v220, v220, v221
    v_accvgpr_write_b32 a132, v218
    v_accvgpr_write_b32 a133, v220
    v_lshlrev_b32 v218, 16, v166
    v_and_b32 v219, 0xffff0000, v166
    v_lshlrev_b32 v220, 16, v167
    v_and_b32 v221, 0xffff0000, v167
    v_mul_f32 v218, s38, v218
    v_mul_f32 v219, s38, v219
    v_mul_f32 v220, s38, v220
    v_mul_f32 v221, s38, v221
    v_cvt_pk_bf16_f32 v218, v218, v219
    v_cvt_pk_bf16_f32 v220, v220, v221
    v_accvgpr_write_b32 a134, v218
    v_accvgpr_write_b32 a135, v220
    v_lshlrev_b32 v218, 16, v168
    v_and_b32 v219, 0xffff0000, v168
    v_lshlrev_b32 v220, 16, v169
    v_and_b32 v221, 0xffff0000, v169
    v_mul_f32 v218, s38, v218
    v_mul_f32 v219, s38, v219
    v_mul_f32 v220, s38, v220
    v_mul_f32 v221, s38, v221
    v_cvt_pk_bf16_f32 v218, v218, v219
    v_cvt_pk_bf16_f32 v220, v220, v221
    v_accvgpr_write_b32 a136, v218
    v_accvgpr_write_b32 a137, v220
    v_lshlrev_b32 v218, 16, v170
    v_and_b32 v219, 0xffff0000, v170
    v_lshlrev_b32 v220, 16, v171
    v_and_b32 v221, 0xffff0000, v171
    v_mul_f32 v218, s38, v218
    v_mul_f32 v219, s38, v219
    v_mul_f32 v220, s38, v220
    v_mul_f32 v221, s38, v221
    v_cvt_pk_bf16_f32 v218, v218, v219
    v_cvt_pk_bf16_f32 v220, v220, v221
    v_accvgpr_write_b32 a138, v218
    v_accvgpr_write_b32 a139, v220
    v_lshlrev_b32 v218, 16, v172
    v_and_b32 v219, 0xffff0000, v172
    v_lshlrev_b32 v220, 16, v173
    v_and_b32 v221, 0xffff0000, v173
    v_mul_f32 v218, s38, v218
    v_mul_f32 v219, s38, v219
    v_mul_f32 v220, s38, v220
    v_mul_f32 v221, s38, v221
    v_cvt_pk_bf16_f32 v218, v218, v219
    v_cvt_pk_bf16_f32 v220, v220, v221
    v_accvgpr_write_b32 a140, v218
    v_accvgpr_write_b32 a141, v220
    v_lshlrev_b32 v218, 16, v174
    v_and_b32 v219, 0xffff0000, v174
    v_lshlrev_b32 v220, 16, v175
    v_and_b32 v221, 0xffff0000, v175
    v_mul_f32 v218, s38, v218
    v_mul_f32 v219, s38, v219
    v_mul_f32 v220, s38, v220
    v_mul_f32 v221, s38, v221
    v_cvt_pk_bf16_f32 v218, v218, v219
    v_cvt_pk_bf16_f32 v220, v220, v221
    v_accvgpr_write_b32 a142, v218
    v_accvgpr_write_b32 a143, v220
    v_mfma_f32_16x16x32_bf16 v[184:187], a[240:243], a[128:131], 0
    v_mfma_f32_16x16x32_bf16 v[184:187], a[244:247], a[132:135], v[184:187]
    v_mfma_f32_16x16x32_bf16 v[184:187], a[248:251], a[136:139], v[184:187]
    v_mfma_f32_16x16x32_bf16 v[184:187], a[252:255], a[140:143], v[184:187]
    s_nop 7
    v_max3_f32 v222, v184, v185, v186
    v_max_f32 v222, v222, v187
    v_mov_b32 v223, v222
    s_nop 1
    v_permlane32_swap_b32 v222, v223
    v_max_f32 v222, v222, v223
    v_mov_b32 v223, v222
    s_nop 1
    v_permlane16_swap_b32 v222, v223
    v_max_f32 v222, v222, v223
    v_sub_f32 v120, 0, v222
    v_sub_f32 v121, 0, v222
    v_sub_f32 v122, 0, v222
    v_sub_f32 v123, 0, v222
    v_add_f32 v184, v184, v120
    v_add_f32 v185, v185, v120
    v_add_f32 v186, v186, v120
    v_add_f32 v187, v187, v120
    v_mfma_f32_16x16x32_bf16 v[188:191], a[208:211], a[128:131], v[120:123]
    v_mfma_f32_16x16x32_bf16 v[188:191], a[212:215], a[132:135], v[188:191]
    v_mfma_f32_16x16x32_bf16 v[188:191], a[216:219], a[136:139], v[188:191]
    v_mfma_f32_16x16x32_bf16 v[188:191], a[220:223], a[140:143], v[188:191]
    v_exp_f32 v184, v184
    v_exp_f32 v185, v185
    v_exp_f32 v186, v186
    v_exp_f32 v187, v187
    v_add_f32 v194, v194, v184
    v_add_f32 v194, v194, v185
    v_add_f32 v194, v194, v186
    v_add_f32 v194, v194, v187
    v_cvt_pk_bf16_f32 v144, v184, v185
    v_cvt_pk_bf16_f32 v145, v186, v187
    v_exp_f32 v188, v188
    v_exp_f32 v189, v189
    v_exp_f32 v190, v190
    v_exp_f32 v191, v191
    v_add_f32 v194, v194, v188
    v_add_f32 v194, v194, v189
    v_add_f32 v194, v194, v190
    v_add_f32 v194, v194, v191
    v_cvt_pk_bf16_f32 v146, v188, v189
    v_cvt_pk_bf16_f32 v147, v190, v191
    s_waitcnt vmcnt(13)
    ds_read_b128 v[160:163], v10 offset:12288
    ds_read_b128 v[164:167], v11 offset:12288
    ds_read_b128 v[168:171], v12 offset:12288
    ds_read_b128 v[172:175], v13 offset:12288
    s_add_u32 s47, s77, 8192
    s_mov_b32 m0, s47
    s_nop 0
    buffer_load_dwordx4 v253, s[20:23], s47 offen nt lds
    buffer_load_dwordx4 v254, s[20:23], s47 offen offset:1024 nt lds
    s_add_u32 m0, s47, 65536
    s_nop 0
    buffer_load_dwordx4 v214, s[24:27], s47 offen nt lds
    buffer_load_dwordx4 v215, s[24:27], s47 offen offset:1024 nt lds
    s_waitcnt lgkmcnt(0)
    v_lshlrev_b32 v218, 16, v160
    v_and_b32 v219, 0xffff0000, v160
    v_lshlrev_b32 v220, 16, v161
    v_and_b32 v221, 0xffff0000, v161
    v_mul_f32 v218, s38, v218
    v_mul_f32 v219, s38, v219
    v_mul_f32 v220, s38, v220
    v_mul_f32 v221, s38, v221
    v_cvt_pk_bf16_f32 v218, v218, v219
    v_cvt_pk_bf16_f32 v220, v220, v221
    v_accvgpr_write_b32 a144, v218
    v_accvgpr_write_b32 a145, v220
    v_lshlrev_b32 v218, 16, v162
    v_and_b32 v219, 0xffff0000, v162
    v_lshlrev_b32 v220, 16, v163
    v_and_b32 v221, 0xffff0000, v163
    v_mul_f32 v218, s38, v218
    v_mul_f32 v219, s38, v219
    v_mul_f32 v220, s38, v220
    v_mul_f32 v221, s38, v221
    v_cvt_pk_bf16_f32 v218, v218, v219
    v_cvt_pk_bf16_f32 v220, v220, v221
    v_accvgpr_write_b32 a146, v218
    v_accvgpr_write_b32 a147, v220
    v_lshlrev_b32 v218, 16, v164
    v_and_b32 v219, 0xffff0000, v164
    v_lshlrev_b32 v220, 16, v165
    v_and_b32 v221, 0xffff0000, v165
    v_mul_f32 v218, s38, v218
    v_mul_f32 v219, s38, v219
    v_mul_f32 v220, s38, v220
    v_mul_f32 v221, s38, v221
    v_cvt_pk_bf16_f32 v218, v218, v219
    v_cvt_pk_bf16_f32 v220, v220, v221
    v_accvgpr_write_b32 a148, v218
    v_accvgpr_write_b32 a149, v220
    v_lshlrev_b32 v218, 16, v166
    v_and_b32 v219, 0xffff0000, v166
    v_lshlrev_b32 v220, 16, v167
    v_and_b32 v221, 0xffff0000, v167
    v_mul_f32 v218, s38, v218
    v_mul_f32 v219, s38, v219
    v_mul_f32 v220, s38, v220
    v_mul_f32 v221, s38, v221
    v_cvt_pk_bf16_f32 v218, v218, v219
    v_cvt_pk_bf16_f32 v220, v220, v221
    v_accvgpr_write_b32 a150, v218
    v_accvgpr_write_b32 a151, v220
    v_lshlrev_b32 v218, 16, v168
    v_and_b32 v219, 0xffff0000, v168
    v_lshlrev_b32 v220, 16, v169
    v_and_b32 v221, 0xffff0000, v169
    v_mul_f32 v218, s38, v218
    v_mul_f32 v219, s38, v219
    v_mul_f32 v220, s38, v220
    v_mul_f32 v221, s38, v221
    v_cvt_pk_bf16_f32 v218, v218, v219
    v_cvt_pk_bf16_f32 v220, v220, v221
    v_accvgpr_write_b32 a152, v218
    v_accvgpr_write_b32 a153, v220
    v_lshlrev_b32 v218, 16, v170
    v_and_b32 v219, 0xffff0000, v170
    v_lshlrev_b32 v220, 16, v171
    v_and_b32 v221, 0xffff0000, v171
    v_mul_f32 v218, s38, v218
    v_mul_f32 v219, s38, v219
    v_mul_f32 v220, s38, v220
    v_mul_f32 v221, s38, v221
    v_cvt_pk_bf16_f32 v218, v218, v219
    v_cvt_pk_bf16_f32 v220, v220, v221
    v_accvgpr_write_b32 a154, v218
    v_accvgpr_write_b32 a155, v220
    v_lshlrev_b32 v218, 16, v172
    v_and_b32 v219, 0xffff0000, v172
    v_lshlrev_b32 v220, 16, v173
    v_and_b32 v221, 0xffff0000, v173
    v_mul_f32 v218, s38, v218
    v_mul_f32 v219, s38, v219
    v_mul_f32 v220, s38, v220
    v_mul_f32 v221, s38, v221
    v_cvt_pk_bf16_f32 v218, v218, v219
    v_cvt_pk_bf16_f32 v220, v220, v221
    v_accvgpr_write_b32 a156, v218
    v_accvgpr_write_b32 a157, v220
    v_lshlrev_b32 v218, 16, v174
    v_and_b32 v219, 0xffff0000, v174
    v_lshlrev_b32 v220, 16, v175
    v_and_b32 v221, 0xffff0000, v175
    v_mul_f32 v218, s38, v218
    v_mul_f32 v219, s38, v219
    v_mul_f32 v220, s38, v220
    v_mul_f32 v221, s38, v221
    v_cvt_pk_bf16_f32 v218, v218, v219
    v_cvt_pk_bf16_f32 v220, v220, v221
    v_accvgpr_write_b32 a158, v218
    v_accvgpr_write_b32 a159, v220
    v_mfma_f32_16x16x32_bf16 v[184:187], a[240:243], a[144:147], 0
    v_mfma_f32_16x16x32_bf16 v[184:187], a[244:247], a[148:151], v[184:187]
    v_mfma_f32_16x16x32_bf16 v[184:187], a[248:251], a[152:155], v[184:187]
    v_mfma_f32_16x16x32_bf16 v[184:187], a[252:255], a[156:159], v[184:187]
    s_nop 7
    v_max3_f32 v222, v184, v185, v186
    v_max_f32 v222, v222, v187
    v_mov_b32 v223, v222
    s_nop 1
    v_permlane32_swap_b32 v222, v223
    v_max_f32 v222, v222, v223
    v_mov_b32 v223, v222
    s_nop 1
    v_permlane16_swap_b32 v222, v223
    v_max_f32 v222, v222, v223
    v_sub_f32 v124, 0, v222
    v_sub_f32 v125, 0, v222
    v_sub_f32 v126, 0, v222
    v_sub_f32 v127, 0, v222
    v_add_f32 v184, v184, v124
    v_add_f32 v185, v185, v124
    v_add_f32 v186, v186, v124
    v_add_f32 v187, v187, v124
    v_mfma_f32_16x16x32_bf16 v[188:191], a[208:211], a[144:147], v[124:127]
    v_mfma_f32_16x16x32_bf16 v[188:191], a[212:215], a[148:151], v[188:191]
    v_mfma_f32_16x16x32_bf16 v[188:191], a[216:219], a[152:155], v[188:191]
    v_mfma_f32_16x16x32_bf16 v[188:191], a[220:223], a[156:159], v[188:191]
    v_exp_f32 v184, v184
    v_exp_f32 v185, v185
    v_exp_f32 v186, v186
    v_exp_f32 v187, v187
    v_add_f32 v195, v195, v184
    v_add_f32 v195, v195, v185
    v_add_f32 v195, v195, v186
    v_add_f32 v195, v195, v187
    v_cvt_pk_bf16_f32 v148, v184, v185
    v_cvt_pk_bf16_f32 v149, v186, v187
    v_exp_f32 v188, v188
    v_exp_f32 v189, v189
    v_exp_f32 v190, v190
    v_exp_f32 v191, v191
    v_add_f32 v195, v195, v188
    v_add_f32 v195, v195, v189
    v_add_f32 v195, v195, v190
    v_add_f32 v195, v195, v191
    v_cvt_pk_bf16_f32 v150, v188, v189
    v_cvt_pk_bf16_f32 v151, v190, v191
    s_waitcnt vmcnt(12)
    ds_read_b128 v[160:163], v10 offset:16384
    ds_read_b128 v[164:167], v11 offset:16384
    ds_read_b128 v[168:171], v12 offset:16384
    ds_read_b128 v[172:175], v13 offset:16384
    s_add_u32 s33, s34, 16384
    s_add_u32 s80, s20, s33
    s_addc_u32 s81, s21, 0
    s_sub_u32 s82, 512000, s33
    s_mov_b32 s83, 0x20000
    s_add_u32 s84, s24, s33
    s_addc_u32 s85, s25, 0
    s_sub_u32 s86, 524288, s33
    s_mov_b32 s87, 0x20000
    s_add_u32 m0, s34, 16384
    s_nop 0
    buffer_load_dwordx4 v210, s[80:83], 0 offen nt lds
    buffer_load_dwordx4 v211, s[80:83], 0 offen offset:1024 nt lds
    buffer_load_dwordx4 v212, s[80:83], 0 offen offset:2048 nt lds
    buffer_load_dwordx4 v213, s[80:83], 0 offen offset:3072 nt lds
    s_add_u32 s80, s80, 16384
    s_addc_u32 s81, s81, 0
    s_sub_i32 s82, s82, 16384
    s_max_i32 s82, s82, 0
    s_waitcnt lgkmcnt(0)
    v_lshlrev_b32 v218, 16, v160
    v_and_b32 v219, 0xffff0000, v160
    v_lshlrev_b32 v220, 16, v161
    v_and_b32 v221, 0xffff0000, v161
    v_mul_f32 v218, s38, v218
    v_mul_f32 v219, s38, v219
    v_mul_f32 v220, s38, v220
    v_mul_f32 v221, s38, v221
    v_cvt_pk_bf16_f32 v218, v218, v219
    v_cvt_pk_bf16_f32 v220, v220, v221
    v_accvgpr_write_b32 a160, v218
    v_accvgpr_write_b32 a161, v220
    v_lshlrev_b32 v218, 16, v162
    v_and_b32 v219, 0xffff0000, v162
    v_lshlrev_b32 v220, 16, v163
    v_and_b32 v221, 0xffff0000, v163
    v_mul_f32 v218, s38, v218
    v_mul_f32 v219, s38, v219
    v_mul_f32 v220, s38, v220
    v_mul_f32 v221, s38, v221
    v_cvt_pk_bf16_f32 v218, v218, v219
    v_cvt_pk_bf16_f32 v220, v220, v221
    v_accvgpr_write_b32 a162, v218
    v_accvgpr_write_b32 a163, v220
    v_lshlrev_b32 v218, 16, v164
    v_and_b32 v219, 0xffff0000, v164
    v_lshlrev_b32 v220, 16, v165
    v_and_b32 v221, 0xffff0000, v165
    v_mul_f32 v218, s38, v218
    v_mul_f32 v219, s38, v219
    v_mul_f32 v220, s38, v220
    v_mul_f32 v221, s38, v221
    v_cvt_pk_bf16_f32 v218, v218, v219
    v_cvt_pk_bf16_f32 v220, v220, v221
    v_accvgpr_write_b32 a164, v218
    v_accvgpr_write_b32 a165, v220
    v_lshlrev_b32 v218, 16, v166
    v_and_b32 v219, 0xffff0000, v166
    v_lshlrev_b32 v220, 16, v167
    v_and_b32 v221, 0xffff0000, v167
    v_mul_f32 v218, s38, v218
    v_mul_f32 v219, s38, v219
    v_mul_f32 v220, s38, v220
    v_mul_f32 v221, s38, v221
    v_cvt_pk_bf16_f32 v218, v218, v219
    v_cvt_pk_bf16_f32 v220, v220, v221
    v_accvgpr_write_b32 a166, v218
    v_accvgpr_write_b32 a167, v220
    v_lshlrev_b32 v218, 16, v168
    v_and_b32 v219, 0xffff0000, v168
    v_lshlrev_b32 v220, 16, v169
    v_and_b32 v221, 0xffff0000, v169
    v_mul_f32 v218, s38, v218
    v_mul_f32 v219, s38, v219
    v_mul_f32 v220, s38, v220
    v_mul_f32 v221, s38, v221
    v_cvt_pk_bf16_f32 v218, v218, v219
    v_cvt_pk_bf16_f32 v220, v220, v221
    v_accvgpr_write_b32 a168, v218
    v_accvgpr_write_b32 a169, v220
    v_lshlrev_b32 v218, 16, v170
    v_and_b32 v219, 0xffff0000, v170
    v_lshlrev_b32 v220, 16, v171
    v_and_b32 v221, 0xffff0000, v171
    v_mul_f32 v218, s38, v218
    v_mul_f32 v219, s38, v219
    v_mul_f32 v220, s38, v220
    v_mul_f32 v221, s38, v221
    v_cvt_pk_bf16_f32 v218, v218, v219
    v_cvt_pk_bf16_f32 v220, v220, v221
    v_accvgpr_write_b32 a170, v218
    v_accvgpr_write_b32 a171, v220
    v_lshlrev_b32 v218, 16, v172
    v_and_b32 v219, 0xffff0000, v172
    v_lshlrev_b32 v220, 16, v173
    v_and_b32 v221, 0xffff0000, v173
    v_mul_f32 v218, s38, v218
    v_mul_f32 v219, s38, v219
    v_mul_f32 v220, s38, v220
    v_mul_f32 v221, s38, v221
    v_cvt_pk_bf16_f32 v218, v218, v219
    v_cvt_pk_bf16_f32 v220, v220, v221
    v_accvgpr_write_b32 a172, v218
    v_accvgpr_write_b32 a173, v220
    v_lshlrev_b32 v218, 16, v174
    v_and_b32 v219, 0xffff0000, v174
    v_lshlrev_b32 v220, 16, v175
    v_and_b32 v221, 0xffff0000, v175
    v_mul_f32 v218, s38, v218
    v_mul_f32 v219, s38, v219
    v_mul_f32 v220, s38, v220
    v_mul_f32 v221, s38, v221
    v_cvt_pk_bf16_f32 v218, v218, v219
    v_cvt_pk_bf16_f32 v220, v220, v221
    v_accvgpr_write_b32 a174, v218
    v_accvgpr_write_b32 a175, v220
    v_mfma_f32_16x16x32_bf16 v[184:187], a[240:243], a[160:163], 0
    v_mfma_f32_16x16x32_bf16 v[184:187], a[244:247], a[164:167], v[184:187]
    v_mfma_f32_16x16x32_bf16 v[184:187], a[248:251], a[168:171], v[184:187]
    v_mfma_f32_16x16x32_bf16 v[184:187], a[252:255], a[172:175], v[184:187]
    s_nop 7
    v_max3_f32 v222, v184, v185, v186
    v_max_f32 v222, v222, v187
    v_mov_b32 v223, v222
    s_nop 1
    v_permlane32_swap_b32 v222, v223
    v_max_f32 v222, v222, v223
    v_mov_b32 v223, v222
    s_nop 1
    v_permlane16_swap_b32 v222, v223
    v_max_f32 v222, v222, v223
    v_sub_f32 v128, 0, v222
    v_sub_f32 v129, 0, v222
    v_sub_f32 v130, 0, v222
    v_sub_f32 v131, 0, v222
    v_add_f32 v184, v184, v128
    v_add_f32 v185, v185, v128
    v_add_f32 v186, v186, v128
    v_add_f32 v187, v187, v128
    v_mfma_f32_16x16x32_bf16 v[188:191], a[208:211], a[160:163], v[128:131]
    v_mfma_f32_16x16x32_bf16 v[188:191], a[212:215], a[164:167], v[188:191]
    v_mfma_f32_16x16x32_bf16 v[188:191], a[216:219], a[168:171], v[188:191]
    v_mfma_f32_16x16x32_bf16 v[188:191], a[220:223], a[172:175], v[188:191]
    v_exp_f32 v184, v184
    v_exp_f32 v185, v185
    v_exp_f32 v186, v186
    v_exp_f32 v187, v187
    v_add_f32 v196, v196, v184
    v_add_f32 v196, v196, v185
    v_add_f32 v196, v196, v186
    v_add_f32 v196, v196, v187
    v_cvt_pk_bf16_f32 v152, v184, v185
    v_cvt_pk_bf16_f32 v153, v186, v187
    v_exp_f32 v188, v188
    v_exp_f32 v189, v189
    v_exp_f32 v190, v190
    v_exp_f32 v191, v191
    v_add_f32 v196, v196, v188
    v_add_f32 v196, v196, v189
    v_add_f32 v196, v196, v190
    v_add_f32 v196, v196, v191
    v_cvt_pk_bf16_f32 v154, v188, v189
    v_cvt_pk_bf16_f32 v155, v190, v191
    s_waitcnt vmcnt(12)
    ds_read_b128 v[160:163], v10
    ds_read_b128 v[164:167], v11
    ds_read_b128 v[168:171], v12
    ds_read_b128 v[172:175], v13
    s_add_u32 m0, s35, 16384
    s_nop 0
    buffer_load_dwordx4 v214, s[84:87], 0 offen nt lds
    buffer_load_dwordx4 v215, s[84:87], 0 offen offset:1024 nt lds
    buffer_load_dwordx4 v214, s[84:87], 0 offen offset:2048 nt lds
    buffer_load_dwordx4 v215, s[84:87], 0 offen offset:3072 nt lds
    s_add_u32 s84, s84, 16384
    s_addc_u32 s85, s85, 0
    s_sub_i32 s86, s86, 16384
    s_max_i32 s86, s86, 0
    s_waitcnt lgkmcnt(0)
    v_lshlrev_b32 v218, 16, v160
    v_and_b32 v219, 0xffff0000, v160
    v_lshlrev_b32 v220, 16, v161
    v_and_b32 v221, 0xffff0000, v161
    v_mul_f32 v218, s38, v218
    v_mul_f32 v219, s38, v219
    v_mul_f32 v220, s38, v220
    v_mul_f32 v221, s38, v221
    v_cvt_pk_bf16_f32 v218, v218, v219
    v_cvt_pk_bf16_f32 v220, v220, v221
    v_accvgpr_write_b32 a176, v218
    v_accvgpr_write_b32 a177, v220
    v_lshlrev_b32 v218, 16, v162
    v_and_b32 v219, 0xffff0000, v162
    v_lshlrev_b32 v220, 16, v163
    v_and_b32 v221, 0xffff0000, v163
    v_mul_f32 v218, s38, v218
    v_mul_f32 v219, s38, v219
    v_mul_f32 v220, s38, v220
    v_mul_f32 v221, s38, v221
    v_cvt_pk_bf16_f32 v218, v218, v219
    v_cvt_pk_bf16_f32 v220, v220, v221
    v_accvgpr_write_b32 a178, v218
    v_accvgpr_write_b32 a179, v220
    v_lshlrev_b32 v218, 16, v164
    v_and_b32 v219, 0xffff0000, v164
    v_lshlrev_b32 v220, 16, v165
    v_and_b32 v221, 0xffff0000, v165
    v_mul_f32 v218, s38, v218
    v_mul_f32 v219, s38, v219
    v_mul_f32 v220, s38, v220
    v_mul_f32 v221, s38, v221
    v_cvt_pk_bf16_f32 v218, v218, v219
    v_cvt_pk_bf16_f32 v220, v220, v221
    v_accvgpr_write_b32 a180, v218
    v_accvgpr_write_b32 a181, v220
    v_lshlrev_b32 v218, 16, v166
    v_and_b32 v219, 0xffff0000, v166
    v_lshlrev_b32 v220, 16, v167
    v_and_b32 v221, 0xffff0000, v167
    v_mul_f32 v218, s38, v218
    v_mul_f32 v219, s38, v219
    v_mul_f32 v220, s38, v220
    v_mul_f32 v221, s38, v221
    v_cvt_pk_bf16_f32 v218, v218, v219
    v_cvt_pk_bf16_f32 v220, v220, v221
    v_accvgpr_write_b32 a182, v218
    v_accvgpr_write_b32 a183, v220
    v_lshlrev_b32 v218, 16, v168
    v_and_b32 v219, 0xffff0000, v168
    v_lshlrev_b32 v220, 16, v169
    v_and_b32 v221, 0xffff0000, v169
    v_mul_f32 v218, s38, v218
    v_mul_f32 v219, s38, v219
    v_mul_f32 v220, s38, v220
    v_mul_f32 v221, s38, v221
    v_cvt_pk_bf16_f32 v218, v218, v219
    v_cvt_pk_bf16_f32 v220, v220, v221
    v_accvgpr_write_b32 a184, v218
    v_accvgpr_write_b32 a185, v220
    v_lshlrev_b32 v218, 16, v170
    v_and_b32 v219, 0xffff0000, v170
    v_lshlrev_b32 v220, 16, v171
    v_and_b32 v221, 0xffff0000, v171
    v_mul_f32 v218, s38, v218
    v_mul_f32 v219, s38, v219
    v_mul_f32 v220, s38, v220
    v_mul_f32 v221, s38, v221
    v_cvt_pk_bf16_f32 v218, v218, v219
    v_cvt_pk_bf16_f32 v220, v220, v221
    v_accvgpr_write_b32 a186, v218
    v_accvgpr_write_b32 a187, v220
    v_lshlrev_b32 v218, 16, v172
    v_and_b32 v219, 0xffff0000, v172
    v_lshlrev_b32 v220, 16, v173
    v_and_b32 v221, 0xffff0000, v173
    v_mul_f32 v218, s38, v218
    v_mul_f32 v219, s38, v219
    v_mul_f32 v220, s38, v220
    v_mul_f32 v221, s38, v221
    v_cvt_pk_bf16_f32 v218, v218, v219
    v_cvt_pk_bf16_f32 v220, v220, v221
    v_accvgpr_write_b32 a188, v218
    v_accvgpr_write_b32 a189, v220
    v_lshlrev_b32 v218, 16, v174
    v_and_b32 v219, 0xffff0000, v174
    v_lshlrev_b32 v220, 16, v175
    v_and_b32 v221, 0xffff0000, v175
    v_mul_f32 v218, s38, v218
    v_mul_f32 v219, s38, v219
    v_mul_f32 v220, s38, v220
    v_mul_f32 v221, s38, v221
    v_cvt_pk_bf16_f32 v218, v218, v219
    v_cvt_pk_bf16_f32 v220, v220, v221
    v_accvgpr_write_b32 a190, v218
    v_accvgpr_write_b32 a191, v220
    v_mfma_f32_16x16x32_bf16 v[184:187], a[240:243], a[176:179], 0
    v_mfma_f32_16x16x32_bf16 v[184:187], a[244:247], a[180:183], v[184:187]
    v_mfma_f32_16x16x32_bf16 v[184:187], a[248:251], a[184:187], v[184:187]
    v_mfma_f32_16x16x32_bf16 v[184:187], a[252:255], a[188:191], v[184:187]
    s_nop 7
    v_max3_f32 v222, v184, v185, v186
    v_max_f32 v222, v222, v187
    v_mov_b32 v223, v222
    s_nop 1
    v_permlane32_swap_b32 v222, v223
    v_max_f32 v222, v222, v223
    v_mov_b32 v223, v222
    s_nop 1
    v_permlane16_swap_b32 v222, v223
    v_max_f32 v222, v222, v223
    v_sub_f32 v132, 0, v222
    v_sub_f32 v133, 0, v222
    v_sub_f32 v134, 0, v222
    v_sub_f32 v135, 0, v222
    v_add_f32 v184, v184, v132
    v_add_f32 v185, v185, v132
    v_add_f32 v186, v186, v132
    v_add_f32 v187, v187, v132
    v_mfma_f32_16x16x32_bf16 v[188:191], a[208:211], a[176:179], v[132:135]
    v_mfma_f32_16x16x32_bf16 v[188:191], a[212:215], a[180:183], v[188:191]
    v_mfma_f32_16x16x32_bf16 v[188:191], a[216:219], a[184:187], v[188:191]
    v_mfma_f32_16x16x32_bf16 v[188:191], a[220:223], a[188:191], v[188:191]
    v_exp_f32 v184, v184
    v_exp_f32 v185, v185
    v_exp_f32 v186, v186
    v_exp_f32 v187, v187
    v_add_f32 v197, v197, v184
    v_add_f32 v197, v197, v185
    v_add_f32 v197, v197, v186
    v_add_f32 v197, v197, v187
    v_cvt_pk_bf16_f32 v156, v184, v185
    v_cvt_pk_bf16_f32 v157, v186, v187
    v_exp_f32 v188, v188
    v_exp_f32 v189, v189
    v_exp_f32 v190, v190
    v_exp_f32 v191, v191
    v_add_f32 v197, v197, v188
    v_add_f32 v197, v197, v189
    v_add_f32 v197, v197, v190
    v_add_f32 v197, v197, v191
    v_cvt_pk_bf16_f32 v158, v188, v189
    v_cvt_pk_bf16_f32 v159, v190, v191
    s_add_u32 s46, s34, 32768
    v_and_b32 v226, 63, v0
    v_lshlrev_b32 v13, 4, v226
    v_add_u32 v9, s46, v210
    v_add_u32 v10, s46, v211
    v_add_u32 v11, s46, v212
    v_add_u32 v12, s46, v213
L_main_entry:
    s_mov_b32 s36, 0
    s_waitcnt vmcnt(12) lgkmcnt(0)
    s_barrier
    ds_read_b64_tr_b16 a[224:225], v202
    ds_read_b64_tr_b16 a[226:227], v202 offset:4096
    ds_read_b64_tr_b16 a[228:229], v203
    ds_read_b64_tr_b16 a[230:231], v203 offset:4096
    v_mfma_f32_16x16x32_bf16 v[184:187], a[192:195], a[96:99], v[112:115]
    v_mfma_f32_16x16x32_bf16 v[184:187], a[196:199], a[100:103], v[184:187]
    v_mfma_f32_16x16x32_bf16 v[184:187], a[200:203], a[104:107], v[184:187]
    ds_read_b64_tr_b16 a[232:233], v204
    v_mfma_f32_16x16x32_bf16 v[184:187], a[204:207], a[108:111], v[184:187]
    s_waitcnt lgkmcnt(3)
    v_mfma_f32_16x16x32_bf16 a[0:3], a[224:227], v[136:139], 0
    ds_read_b64_tr_b16 a[234:235], v204 offset:4096
    v_mfma_f32_16x16x32_bf16 a[4:7], a[224:227], v[140:143], 0
    v_mfma_f32_16x16x32_bf16 a[8:11], a[224:227], v[144:147], 0
    v_mfma_f32_16x16x32_bf16 a[12:15], a[224:227], v[148:151], 0
    s_nop 1
    v_mfma_f32_16x16x32_bf16 v[188:191], a[192:195], a[112:115], v[116:119]
    v_exp_f32 v184, v184
    v_mfma_f32_16x16x32_bf16 v[188:191], a[196:199], a[116:119], v[188:191]
    v_exp_f32 v185, v185
    v_mfma_f32_16x16x32_bf16 v[188:191], a[200:203], a[120:123], v[188:191]
    ds_read_b64_tr_b16 a[236:237], v205
    v_add_f32 v192, v192, v184
    v_mfma_f32_16x16x32_bf16 v[188:191], a[204:207], a[124:127], v[188:191]
    v_exp_f32 v186, v186
    v_mfma_f32_16x16x32_bf16 a[16:19], a[224:227], v[152:155], 0
    ds_read_b64_tr_b16 a[238:239], v205 offset:4096
    v_cvt_pk_bf16_f32 v160, v184, v185
    v_mfma_f32_16x16x32_bf16 a[20:23], a[224:227], v[156:159], 0
    s_waitcnt lgkmcnt(4)
    v_exp_f32 v187, v187
    v_mfma_f32_16x16x32_bf16 a[24:27], a[228:231], v[136:139], 0
    v_add_f32 v192, v192, v185
    v_add_f32 v192, v192, v186
    v_mfma_f32_16x16x32_bf16 a[28:31], a[228:231], v[140:143], 0
    v_add_f32 v192, v192, v187
    v_cvt_pk_bf16_f32 v161, v186, v187
    v_mfma_f32_16x16x32_bf16 v[184:187], a[192:195], a[128:131], v[120:123]
    v_exp_f32 v188, v188
    v_mfma_f32_16x16x32_bf16 v[184:187], a[196:199], a[132:135], v[184:187]
    v_exp_f32 v189, v189
    v_mfma_f32_16x16x32_bf16 v[184:187], a[200:203], a[136:139], v[184:187]
    ds_read_b128 a[208:211], v198
    v_add_f32 v193, v193, v188
    v_mfma_f32_16x16x32_bf16 v[184:187], a[204:207], a[140:143], v[184:187]
    v_exp_f32 v190, v190
    v_mfma_f32_16x16x32_bf16 a[32:35], a[228:231], v[144:147], 0
    ds_read_b128 a[212:215], v199
    v_cvt_pk_bf16_f32 v164, v188, v189
    v_mfma_f32_16x16x32_bf16 a[36:39], a[228:231], v[148:151], 0
    v_exp_f32 v191, v191
    v_mfma_f32_16x16x32_bf16 a[40:43], a[228:231], v[152:155], 0
    v_add_f32 v193, v193, v189
    v_add_f32 v193, v193, v190
    v_mfma_f32_16x16x32_bf16 a[44:47], a[228:231], v[156:159], 0
    v_add_f32 v193, v193, v191
    v_cvt_pk_bf16_f32 v165, v190, v191
    v_mfma_f32_16x16x32_bf16 v[188:191], a[192:195], a[144:147], v[124:127]
    v_exp_f32 v184, v184
    v_mfma_f32_16x16x32_bf16 v[188:191], a[196:199], a[148:151], v[188:191]
    v_exp_f32 v185, v185
    v_mfma_f32_16x16x32_bf16 v[188:191], a[200:203], a[152:155], v[188:191]
    ds_read_b64_tr_b16 a[224:225], v206
    v_add_f32 v194, v194, v184
    v_mfma_f32_16x16x32_bf16 v[188:191], a[204:207], a[156:159], v[188:191]
    s_waitcnt lgkmcnt(5)
    v_exp_f32 v186, v186
    v_mfma_f32_16x16x32_bf16 a[48:51], a[232:235], v[136:139], 0
    ds_read_b64_tr_b16 a[226:227], v206 offset:4096
    v_cvt_pk_bf16_f32 v168, v184, v185
    v_mfma_f32_16x16x32_bf16 a[52:55], a[232:235], v[140:143], 0
    v_exp_f32 v187, v187
    v_mfma_f32_16x16x32_bf16 a[56:59], a[232:235], v[144:147], 0
    v_add_f32 v194, v194, v185
    v_add_f32 v194, v194, v186
    v_mfma_f32_16x16x32_bf16 a[60:63], a[232:235], v[148:151], 0
    v_add_f32 v194, v194, v187
    v_cvt_pk_bf16_f32 v169, v186, v187
    v_mfma_f32_16x16x32_bf16 v[184:187], a[192:195], a[160:163], v[128:131]
    v_exp_f32 v188, v188
    v_mfma_f32_16x16x32_bf16 v[184:187], a[196:199], a[164:167], v[184:187]
    v_exp_f32 v189, v189
    v_mfma_f32_16x16x32_bf16 v[184:187], a[200:203], a[168:171], v[184:187]
    ds_read_b128 a[216:219], v200
    v_add_f32 v195, v195, v188
    v_mfma_f32_16x16x32_bf16 v[184:187], a[204:207], a[172:175], v[184:187]
    v_exp_f32 v190, v190
    v_mfma_f32_16x16x32_bf16 a[64:67], a[232:235], v[152:155], 0
    ds_read_b128 a[220:223], v201
    v_cvt_pk_bf16_f32 v172, v188, v189
    v_mfma_f32_16x16x32_bf16 a[68:71], a[232:235], v[156:159], 0
    s_waitcnt lgkmcnt(6)
    v_exp_f32 v191, v191
    v_mfma_f32_16x16x32_bf16 a[72:75], a[236:239], v[136:139], 0
    v_add_f32 v195, v195, v189
    v_add_f32 v195, v195, v190
    v_mfma_f32_16x16x32_bf16 a[76:79], a[236:239], v[140:143], 0
    v_add_f32 v195, v195, v191
    v_cvt_pk_bf16_f32 v173, v190, v191
    v_mfma_f32_16x16x32_bf16 v[188:191], a[192:195], a[176:179], v[132:135]
    v_exp_f32 v184, v184
    v_mfma_f32_16x16x32_bf16 v[188:191], a[196:199], a[180:183], v[188:191]
    v_exp_f32 v185, v185
    v_mfma_f32_16x16x32_bf16 v[188:191], a[200:203], a[184:187], v[188:191]
    ds_read_b64_tr_b16 a[228:229], v207
    v_add_f32 v196, v196, v184
    v_mfma_f32_16x16x32_bf16 v[188:191], a[204:207], a[188:191], v[188:191]
    v_exp_f32 v186, v186
    v_mfma_f32_16x16x32_bf16 a[80:83], a[236:239], v[144:147], 0
    ds_read_b64_tr_b16 a[230:231], v207 offset:4096
    v_cvt_pk_bf16_f32 v176, v184, v185
    v_mfma_f32_16x16x32_bf16 a[84:87], a[236:239], v[148:151], 0
    v_exp_f32 v187, v187
    v_mfma_f32_16x16x32_bf16 a[88:91], a[236:239], v[152:155], 0
    v_add_f32 v196, v196, v185
    v_add_f32 v196, v196, v186
    v_mfma_f32_16x16x32_bf16 a[92:95], a[236:239], v[156:159], 0
    s_waitcnt lgkmcnt(2)
    v_add_f32 v196, v196, v187
    v_cvt_pk_bf16_f32 v177, v186, v187
    v_mfma_f32_16x16x32_bf16 v[184:187], a[208:211], a[96:99], v[112:115]
    v_exp_f32 v188, v188
    v_mfma_f32_16x16x32_bf16 v[184:187], a[212:215], a[100:103], v[184:187]
    v_exp_f32 v189, v189
    v_mfma_f32_16x16x32_bf16 v[184:187], a[216:219], a[104:107], v[184:187]
    ds_read_b64_tr_b16 a[232:233], v208
    v_add_f32 v197, v197, v188
    v_mfma_f32_16x16x32_bf16 v[184:187], a[220:223], a[108:111], v[184:187]
    v_exp_f32 v190, v190
    v_mfma_f32_16x16x32_bf16 v[16:19], a[224:227], v[136:139], 0
    ds_read_b64_tr_b16 a[234:235], v208 offset:4096
    v_cvt_pk_bf16_f32 v180, v188, v189
    v_mfma_f32_16x16x32_bf16 v[20:23], a[224:227], v[140:143], 0
    v_exp_f32 v191, v191
    v_mfma_f32_16x16x32_bf16 v[24:27], a[224:227], v[144:147], 0
    v_add_f32 v197, v197, v189
    v_add_f32 v197, v197, v190
    v_mfma_f32_16x16x32_bf16 v[28:31], a[224:227], v[148:151], 0
    v_add_f32 v197, v197, v191
    v_cvt_pk_bf16_f32 v181, v190, v191
    v_mfma_f32_16x16x32_bf16 v[188:191], a[208:211], a[112:115], v[116:119]
    v_exp_f32 v184, v184
    v_mfma_f32_16x16x32_bf16 v[188:191], a[212:215], a[116:119], v[188:191]
    v_exp_f32 v185, v185
    v_mfma_f32_16x16x32_bf16 v[188:191], a[216:219], a[120:123], v[188:191]
    ds_read_b64_tr_b16 a[236:237], v209
    v_add_f32 v192, v192, v184
    v_mfma_f32_16x16x32_bf16 v[188:191], a[220:223], a[124:127], v[188:191]
    v_exp_f32 v186, v186
    v_mfma_f32_16x16x32_bf16 v[32:35], a[224:227], v[152:155], 0
    ds_read_b64_tr_b16 a[238:239], v209 offset:4096
    v_cvt_pk_bf16_f32 v162, v184, v185
    v_mfma_f32_16x16x32_bf16 v[36:39], a[224:227], v[156:159], 0
    s_waitcnt lgkmcnt(4)
    v_exp_f32 v187, v187
    v_mfma_f32_16x16x32_bf16 v[40:43], a[228:231], v[136:139], 0
    v_add_f32 v192, v192, v185
    v_add_f32 v192, v192, v186
    v_mfma_f32_16x16x32_bf16 v[44:47], a[228:231], v[140:143], 0
    v_add_f32 v192, v192, v187
    v_cvt_pk_bf16_f32 v163, v186, v187
    v_mfma_f32_16x16x32_bf16 v[184:187], a[208:211], a[128:131], v[120:123]
    v_exp_f32 v188, v188
    v_mfma_f32_16x16x32_bf16 v[184:187], a[212:215], a[132:135], v[184:187]
    v_exp_f32 v189, v189
    v_mfma_f32_16x16x32_bf16 v[184:187], a[216:219], a[136:139], v[184:187]
    ds_read_b128 a[192:195], v198 offset:4096
    v_add_f32 v193, v193, v188
    v_mfma_f32_16x16x32_bf16 v[184:187], a[220:223], a[140:143], v[184:187]
    v_exp_f32 v190, v190
    v_mfma_f32_16x16x32_bf16 v[48:51], a[228:231], v[144:147], 0
    ds_read_b128 a[196:199], v199 offset:4096
    v_cvt_pk_bf16_f32 v166, v188, v189
    v_mfma_f32_16x16x32_bf16 v[52:55], a[228:231], v[148:151], 0
    v_exp_f32 v191, v191
    v_mfma_f32_16x16x32_bf16 v[56:59], a[228:231], v[152:155], 0
    v_add_f32 v193, v193, v189
    v_add_f32 v193, v193, v190
    v_mfma_f32_16x16x32_bf16 v[60:63], a[228:231], v[156:159], 0
    v_add_f32 v193, v193, v191
    v_cvt_pk_bf16_f32 v167, v190, v191
    v_mfma_f32_16x16x32_bf16 v[188:191], a[208:211], a[144:147], v[124:127]
    v_exp_f32 v184, v184
    v_mfma_f32_16x16x32_bf16 v[188:191], a[212:215], a[148:151], v[188:191]
    v_exp_f32 v185, v185
    v_mfma_f32_16x16x32_bf16 v[188:191], a[216:219], a[152:155], v[188:191]
    ds_read_b128 a[200:203], v200 offset:4096
    v_add_f32 v194, v194, v184
    v_mfma_f32_16x16x32_bf16 v[188:191], a[220:223], a[156:159], v[188:191]
    s_waitcnt lgkmcnt(5)
    v_exp_f32 v186, v186
    v_mfma_f32_16x16x32_bf16 v[64:67], a[232:235], v[136:139], 0
    ds_read_b128 a[204:207], v201 offset:4096
    v_cvt_pk_bf16_f32 v170, v184, v185
    v_mfma_f32_16x16x32_bf16 v[68:71], a[232:235], v[140:143], 0
    v_exp_f32 v187, v187
    v_mfma_f32_16x16x32_bf16 v[72:75], a[232:235], v[144:147], 0
    v_add_f32 v194, v194, v185
    v_add_f32 v194, v194, v186
    v_mfma_f32_16x16x32_bf16 v[76:79], a[232:235], v[148:151], 0
    v_add_f32 v194, v194, v187
    v_cvt_pk_bf16_f32 v171, v186, v187
    v_mfma_f32_16x16x32_bf16 v[184:187], a[208:211], a[160:163], v[128:131]
    s_waitcnt vmcnt(8) lgkmcnt(0)
    v_exp_f32 v188, v188
    v_mfma_f32_16x16x32_bf16 v[184:187], a[212:215], a[164:167], v[184:187]
    s_barrier
    v_exp_f32 v189, v189
    v_mfma_f32_16x16x32_bf16 v[184:187], a[216:219], a[168:171], v[184:187]
    ds_read_b64_tr_b16 a[224:225], v202 offset:8192
    v_add_f32 v195, v195, v188
    v_mfma_f32_16x16x32_bf16 v[184:187], a[220:223], a[172:175], v[184:187]
    v_exp_f32 v190, v190
    v_mfma_f32_16x16x32_bf16 v[80:83], a[232:235], v[152:155], 0
    ds_read_b64_tr_b16 a[226:227], v202 offset:12288
    v_cvt_pk_bf16_f32 v174, v188, v189
    v_mfma_f32_16x16x32_bf16 v[84:87], a[232:235], v[156:159], 0
    v_exp_f32 v191, v191
    v_mfma_f32_16x16x32_bf16 v[88:91], a[236:239], v[136:139], 0
    v_add_f32 v195, v195, v189
    v_add_f32 v195, v195, v190
    v_mfma_f32_16x16x32_bf16 v[92:95], a[236:239], v[140:143], 0
    v_add_f32 v195, v195, v191
    v_cvt_pk_bf16_f32 v175, v190, v191
    v_mfma_f32_16x16x32_bf16 v[188:191], a[208:211], a[176:179], v[132:135]
    v_exp_f32 v184, v184
    v_mfma_f32_16x16x32_bf16 v[188:191], a[212:215], a[180:183], v[188:191]
    v_exp_f32 v185, v185
    v_mfma_f32_16x16x32_bf16 v[188:191], a[216:219], a[184:187], v[188:191]
    ds_read_b64_tr_b16 a[228:229], v203 offset:8192
    v_add_f32 v196, v196, v184
    v_mfma_f32_16x16x32_bf16 v[188:191], a[220:223], a[188:191], v[188:191]
    v_exp_f32 v186, v186
    v_mfma_f32_16x16x32_bf16 v[96:99], a[236:239], v[144:147], 0
    ds_read_b64_tr_b16 a[230:231], v203 offset:12288
    v_cvt_pk_bf16_f32 v178, v184, v185
    v_mfma_f32_16x16x32_bf16 v[100:103], a[236:239], v[148:151], 0
    v_exp_f32 v187, v187
    v_mfma_f32_16x16x32_bf16 v[104:107], a[236:239], v[152:155], 0
    v_add_f32 v196, v196, v185
    v_add_f32 v196, v196, v186
    v_mfma_f32_16x16x32_bf16 v[108:111], a[236:239], v[156:159], 0
    v_add_f32 v196, v196, v187
    v_cvt_pk_bf16_f32 v179, v186, v187
    v_mfma_f32_16x16x32_bf16 v[184:187], a[192:195], a[96:99], v[112:115]
    s_mov_b32 m0, s90
    v_exp_f32 v188, v188
    v_mfma_f32_16x16x32_bf16 v[184:187], a[196:199], a[100:103], v[184:187]
    buffer_load_dwordx4 v210, s[80:83], 0 offen nt lds
    v_exp_f32 v189, v189
    v_mfma_f32_16x16x32_bf16 v[184:187], a[200:203], a[104:107], v[184:187]
    ds_read_b64_tr_b16 a[232:233], v204 offset:8192
    v_add_f32 v197, v197, v188
    v_mfma_f32_16x16x32_bf16 v[184:187], a[204:207], a[108:111], v[184:187]
    s_waitcnt lgkmcnt(3)
    v_exp_f32 v190, v190
    v_mfma_f32_16x16x32_bf16 a[0:3], a[224:227], v[160:163], a[0:3]
    ds_read_b64_tr_b16 a[234:235], v204 offset:12288
    v_cvt_pk_bf16_f32 v182, v188, v189
    v_mfma_f32_16x16x32_bf16 a[4:7], a[224:227], v[164:167], a[4:7]
    v_exp_f32 v191, v191
    v_mfma_f32_16x16x32_bf16 a[8:11], a[224:227], v[168:171], a[8:11]
    v_add_f32 v197, v197, v189
    v_add_f32 v197, v197, v190
    v_mfma_f32_16x16x32_bf16 a[12:15], a[224:227], v[172:175], a[12:15]
    v_add_f32 v197, v197, v191
    v_cvt_pk_bf16_f32 v183, v190, v191
    v_mfma_f32_16x16x32_bf16 v[188:191], a[192:195], a[112:115], v[116:119]
    v_exp_f32 v184, v184
    v_mfma_f32_16x16x32_bf16 v[188:191], a[196:199], a[116:119], v[188:191]
    v_exp_f32 v185, v185
    v_mfma_f32_16x16x32_bf16 v[188:191], a[200:203], a[120:123], v[188:191]
    ds_read_b64_tr_b16 a[236:237], v205 offset:8192
    v_add_f32 v192, v192, v184
    v_mfma_f32_16x16x32_bf16 v[188:191], a[204:207], a[124:127], v[188:191]
    buffer_load_dwordx4 v211, s[80:83], 0 offen offset:1024 nt lds
    v_exp_f32 v186, v186
    v_mfma_f32_16x16x32_bf16 a[16:19], a[224:227], v[176:179], a[16:19]
    ds_read_b64_tr_b16 a[238:239], v205 offset:12288
    v_cvt_pk_bf16_f32 v136, v184, v185
    v_mfma_f32_16x16x32_bf16 a[20:23], a[224:227], v[180:183], a[20:23]
    s_waitcnt lgkmcnt(4)
    v_exp_f32 v187, v187
    v_mfma_f32_16x16x32_bf16 a[24:27], a[228:231], v[160:163], a[24:27]
    v_add_f32 v192, v192, v185
    v_add_f32 v192, v192, v186
    v_mfma_f32_16x16x32_bf16 a[28:31], a[228:231], v[164:167], a[28:31]
    v_add_f32 v192, v192, v187
    v_cvt_pk_bf16_f32 v137, v186, v187
    v_mfma_f32_16x16x32_bf16 v[184:187], a[192:195], a[128:131], v[120:123]
    v_exp_f32 v188, v188
    v_mfma_f32_16x16x32_bf16 v[184:187], a[196:199], a[132:135], v[184:187]
    v_exp_f32 v189, v189
    v_mfma_f32_16x16x32_bf16 v[184:187], a[200:203], a[136:139], v[184:187]
    ds_read_b128 a[208:211], v198 offset:8192
    v_add_f32 v193, v193, v188
    v_mfma_f32_16x16x32_bf16 v[184:187], a[204:207], a[140:143], v[184:187]
    buffer_load_dwordx4 v212, s[80:83], 0 offen offset:2048 nt lds
    v_exp_f32 v190, v190
    v_mfma_f32_16x16x32_bf16 a[32:35], a[228:231], v[168:171], a[32:35]
    ds_read_b128 a[212:215], v199 offset:8192
    v_cvt_pk_bf16_f32 v140, v188, v189
    v_mfma_f32_16x16x32_bf16 a[36:39], a[228:231], v[172:175], a[36:39]
    v_exp_f32 v191, v191
    v_mfma_f32_16x16x32_bf16 a[40:43], a[228:231], v[176:179], a[40:43]
    v_add_f32 v193, v193, v189
    v_add_f32 v193, v193, v190
    v_mfma_f32_16x16x32_bf16 a[44:47], a[228:231], v[180:183], a[44:47]
    v_add_f32 v193, v193, v191
    v_cvt_pk_bf16_f32 v141, v190, v191
    v_mfma_f32_16x16x32_bf16 v[188:191], a[192:195], a[144:147], v[124:127]
    v_exp_f32 v184, v184
    v_mfma_f32_16x16x32_bf16 v[188:191], a[196:199], a[148:151], v[188:191]
    buffer_load_dwordx4 v213, s[80:83], 0 offen offset:3072 nt lds
    v_exp_f32 v185, v185
    v_mfma_f32_16x16x32_bf16 v[188:191], a[200:203], a[152:155], v[188:191]
    ds_read_b64_tr_b16 a[224:225], v206 offset:8192
    v_add_f32 v194, v194, v184
    v_mfma_f32_16x16x32_bf16 v[188:191], a[204:207], a[156:159], v[188:191]
    s_waitcnt lgkmcnt(5)
    v_exp_f32 v186, v186
    v_mfma_f32_16x16x32_bf16 a[48:51], a[232:235], v[160:163], a[48:51]
    ds_read_b64_tr_b16 a[226:227], v206 offset:12288
    v_cvt_pk_bf16_f32 v144, v184, v185
    v_mfma_f32_16x16x32_bf16 a[52:55], a[232:235], v[164:167], a[52:55]
    s_add_u32 s80, s80, 16384
    v_exp_f32 v187, v187
    v_mfma_f32_16x16x32_bf16 a[56:59], a[232:235], v[168:171], a[56:59]
    s_addc_u32 s81, s81, 0
    v_add_f32 v194, v194, v185
    v_add_f32 v194, v194, v186
    v_mfma_f32_16x16x32_bf16 a[60:63], a[232:235], v[172:175], a[60:63]
    s_sub_i32 s82, s82, 16384
    v_add_f32 v194, v194, v187
    v_cvt_pk_bf16_f32 v145, v186, v187
    v_mfma_f32_16x16x32_bf16 v[184:187], a[192:195], a[160:163], v[128:131]
    s_max_i32 s82, s82, 0
    v_exp_f32 v188, v188
    v_mfma_f32_16x16x32_bf16 v[184:187], a[196:199], a[164:167], v[184:187]
    s_mov_b32 m0, s94
    v_exp_f32 v189, v189
    v_mfma_f32_16x16x32_bf16 v[184:187], a[200:203], a[168:171], v[184:187]
    ds_read_b128 a[216:219], v200 offset:8192
    v_add_f32 v195, v195, v188
    v_mfma_f32_16x16x32_bf16 v[184:187], a[204:207], a[172:175], v[184:187]
    buffer_load_dwordx4 v214, s[84:87], 0 offen nt lds
    v_exp_f32 v190, v190
    v_mfma_f32_16x16x32_bf16 a[64:67], a[232:235], v[176:179], a[64:67]
    ds_read_b128 a[220:223], v201 offset:8192
    v_cvt_pk_bf16_f32 v148, v188, v189
    v_mfma_f32_16x16x32_bf16 a[68:71], a[232:235], v[180:183], a[68:71]
    s_waitcnt lgkmcnt(6)
    v_exp_f32 v191, v191
    v_mfma_f32_16x16x32_bf16 a[72:75], a[236:239], v[160:163], a[72:75]
    v_add_f32 v195, v195, v189
    v_add_f32 v195, v195, v190
    v_mfma_f32_16x16x32_bf16 a[76:79], a[236:239], v[164:167], a[76:79]
    v_add_f32 v195, v195, v191
    v_cvt_pk_bf16_f32 v149, v190, v191
    v_mfma_f32_16x16x32_bf16 v[188:191], a[192:195], a[176:179], v[132:135]
    v_exp_f32 v184, v184
    v_mfma_f32_16x16x32_bf16 v[188:191], a[196:199], a[180:183], v[188:191]
    v_exp_f32 v185, v185
    v_mfma_f32_16x16x32_bf16 v[188:191], a[200:203], a[184:187], v[188:191]
    ds_read_b64_tr_b16 a[228:229], v207 offset:8192
    v_add_f32 v196, v196, v184
    v_mfma_f32_16x16x32_bf16 v[188:191], a[204:207], a[188:191], v[188:191]
    buffer_load_dwordx4 v215, s[84:87], 0 offen offset:1024 nt lds
    v_exp_f32 v186, v186
    v_mfma_f32_16x16x32_bf16 a[80:83], a[236:239], v[168:171], a[80:83]
    ds_read_b64_tr_b16 a[230:231], v207 offset:12288
    v_cvt_pk_bf16_f32 v152, v184, v185
    v_mfma_f32_16x16x32_bf16 a[84:87], a[236:239], v[172:175], a[84:87]
    v_exp_f32 v187, v187
    v_mfma_f32_16x16x32_bf16 a[88:91], a[236:239], v[176:179], a[88:91]
    v_add_f32 v196, v196, v185
    v_add_f32 v196, v196, v186
    v_mfma_f32_16x16x32_bf16 a[92:95], a[236:239], v[180:183], a[92:95]
    s_waitcnt lgkmcnt(2)
    v_add_f32 v196, v196, v187
    v_cvt_pk_bf16_f32 v153, v186, v187
    v_mfma_f32_16x16x32_bf16 v[184:187], a[208:211], a[96:99], v[112:115]
    v_exp_f32 v188, v188
    v_mfma_f32_16x16x32_bf16 v[184:187], a[212:215], a[100:103], v[184:187]
    buffer_load_dwordx4 v214, s[84:87], 0 offen offset:2048 nt lds
    v_exp_f32 v189, v189
    v_mfma_f32_16x16x32_bf16 v[184:187], a[216:219], a[104:107], v[184:187]
    ds_read_b64_tr_b16 a[232:233], v208 offset:8192
    v_add_f32 v197, v197, v188
    v_mfma_f32_16x16x32_bf16 v[184:187], a[220:223], a[108:111], v[184:187]
    v_exp_f32 v190, v190
    v_mfma_f32_16x16x32_bf16 v[16:19], a[224:227], v[160:163], v[16:19]
    ds_read_b64_tr_b16 a[234:235], v208 offset:12288
    v_cvt_pk_bf16_f32 v156, v188, v189
    v_mfma_f32_16x16x32_bf16 v[20:23], a[224:227], v[164:167], v[20:23]
    v_exp_f32 v191, v191
    v_mfma_f32_16x16x32_bf16 v[24:27], a[224:227], v[168:171], v[24:27]
    v_add_f32 v197, v197, v189
    v_add_f32 v197, v197, v190
    v_mfma_f32_16x16x32_bf16 v[28:31], a[224:227], v[172:175], v[28:31]
    v_add_f32 v197, v197, v191
    v_cvt_pk_bf16_f32 v157, v190, v191
    v_mfma_f32_16x16x32_bf16 v[188:191], a[208:211], a[112:115], v[116:119]
    v_exp_f32 v184, v184
    v_mfma_f32_16x16x32_bf16 v[188:191], a[212:215], a[116:119], v[188:191]
    v_exp_f32 v185, v185
    v_mfma_f32_16x16x32_bf16 v[188:191], a[216:219], a[120:123], v[188:191]
    ds_read_b64_tr_b16 a[236:237], v209 offset:8192
    v_add_f32 v192, v192, v184
    v_mfma_f32_16x16x32_bf16 v[188:191], a[220:223], a[124:127], v[188:191]
    buffer_load_dwordx4 v215, s[84:87], 0 offen offset:3072 nt lds
    v_exp_f32 v186, v186
    v_mfma_f32_16x16x32_bf16 v[32:35], a[224:227], v[176:179], v[32:35]
    ds_read_b64_tr_b16 a[238:239], v209 offset:12288
    v_cvt_pk_bf16_f32 v138, v184, v185
    v_mfma_f32_16x16x32_bf16 v[36:39], a[224:227], v[180:183], v[36:39]
    s_waitcnt lgkmcnt(4)
    v_exp_f32 v187, v187
    v_mfma_f32_16x16x32_bf16 v[40:43], a[228:231], v[160:163], v[40:43]
    s_add_u32 s84, s84, 16384
    v_add_f32 v192, v192, v185
    v_add_f32 v192, v192, v186
    v_mfma_f32_16x16x32_bf16 v[44:47], a[228:231], v[164:167], v[44:47]
    s_addc_u32 s85, s85, 0
    v_add_f32 v192, v192, v187
    v_cvt_pk_bf16_f32 v139, v186, v187
    v_mfma_f32_16x16x32_bf16 v[184:187], a[208:211], a[128:131], v[120:123]
    s_sub_i32 s86, s86, 16384
    v_exp_f32 v188, v188
    v_mfma_f32_16x16x32_bf16 v[184:187], a[212:215], a[132:135], v[184:187]
    s_max_i32 s86, s86, 0
    v_exp_f32 v189, v189
    v_mfma_f32_16x16x32_bf16 v[184:187], a[216:219], a[136:139], v[184:187]
    s_mov_b32 m0, s91
    ds_read_b128 a[192:195], v198 offset:12288
    v_add_f32 v193, v193, v188
    v_mfma_f32_16x16x32_bf16 v[184:187], a[220:223], a[140:143], v[184:187]
    buffer_load_dwordx4 v210, s[80:83], 0 offen nt lds
    v_exp_f32 v190, v190
    v_mfma_f32_16x16x32_bf16 v[48:51], a[228:231], v[168:171], v[48:51]
    ds_read_b128 a[196:199], v199 offset:12288
    v_cvt_pk_bf16_f32 v142, v188, v189
    v_mfma_f32_16x16x32_bf16 v[52:55], a[228:231], v[172:175], v[52:55]
    v_exp_f32 v191, v191
    v_mfma_f32_16x16x32_bf16 v[56:59], a[228:231], v[176:179], v[56:59]
    buffer_load_dwordx4 v211, s[80:83], 0 offen offset:1024 nt lds
    v_add_f32 v193, v193, v189
    v_add_f32 v193, v193, v190
    v_mfma_f32_16x16x32_bf16 v[60:63], a[228:231], v[180:183], v[60:63]
    v_add_f32 v193, v193, v191
    v_cvt_pk_bf16_f32 v143, v190, v191
    v_mfma_f32_16x16x32_bf16 v[188:191], a[208:211], a[144:147], v[124:127]
    v_exp_f32 v184, v184
    v_mfma_f32_16x16x32_bf16 v[188:191], a[212:215], a[148:151], v[188:191]
    buffer_load_dwordx4 v212, s[80:83], 0 offen offset:2048 nt lds
    v_exp_f32 v185, v185
    v_mfma_f32_16x16x32_bf16 v[188:191], a[216:219], a[152:155], v[188:191]
    ds_read_b128 a[200:203], v200 offset:12288
    v_add_f32 v194, v194, v184
    v_mfma_f32_16x16x32_bf16 v[188:191], a[220:223], a[156:159], v[188:191]
    s_waitcnt lgkmcnt(5)
    v_exp_f32 v186, v186
    v_mfma_f32_16x16x32_bf16 v[64:67], a[232:235], v[160:163], v[64:67]
    ds_read_b128 a[204:207], v201 offset:12288
    v_cvt_pk_bf16_f32 v146, v184, v185
    v_mfma_f32_16x16x32_bf16 v[68:71], a[232:235], v[164:167], v[68:71]
    v_exp_f32 v187, v187
    v_mfma_f32_16x16x32_bf16 v[72:75], a[232:235], v[168:171], v[72:75]
    buffer_load_dwordx4 v213, s[80:83], 0 offen offset:3072 nt lds
    v_add_f32 v194, v194, v185
    v_add_f32 v194, v194, v186
    v_mfma_f32_16x16x32_bf16 v[76:79], a[232:235], v[172:175], v[76:79]
    s_add_u32 s80, s80, 16384
    v_add_f32 v194, v194, v187
    v_cvt_pk_bf16_f32 v147, v186, v187
    v_mfma_f32_16x16x32_bf16 v[184:187], a[208:211], a[160:163], v[128:131]
    s_waitcnt vmcnt(12) lgkmcnt(0)
    v_exp_f32 v188, v188
    v_mfma_f32_16x16x32_bf16 v[184:187], a[212:215], a[164:167], v[184:187]
    s_barrier
    v_exp_f32 v189, v189
    v_mfma_f32_16x16x32_bf16 v[184:187], a[216:219], a[168:171], v[184:187]
    s_mov_b32 m0, s95
    ds_read_b64_tr_b16 a[224:225], v202 offset:16384
    v_add_f32 v195, v195, v188
    v_mfma_f32_16x16x32_bf16 v[184:187], a[220:223], a[172:175], v[184:187]
    buffer_load_dwordx4 v214, s[84:87], 0 offen nt lds
    v_exp_f32 v190, v190
    v_mfma_f32_16x16x32_bf16 v[80:83], a[232:235], v[176:179], v[80:83]
    ds_read_b64_tr_b16 a[226:227], v202 offset:20480
    v_cvt_pk_bf16_f32 v150, v188, v189
    v_mfma_f32_16x16x32_bf16 v[84:87], a[232:235], v[180:183], v[84:87]
    v_exp_f32 v191, v191
    v_mfma_f32_16x16x32_bf16 v[88:91], a[236:239], v[160:163], v[88:91]
    buffer_load_dwordx4 v215, s[84:87], 0 offen offset:1024 nt lds
    v_add_f32 v195, v195, v189
    v_add_f32 v195, v195, v190
    v_mfma_f32_16x16x32_bf16 v[92:95], a[236:239], v[164:167], v[92:95]
    s_addc_u32 s81, s81, 0
    v_add_f32 v195, v195, v191
    v_cvt_pk_bf16_f32 v151, v190, v191
    v_mfma_f32_16x16x32_bf16 v[188:191], a[208:211], a[176:179], v[132:135]
    s_sub_i32 s82, s82, 16384
    v_exp_f32 v184, v184
    v_mfma_f32_16x16x32_bf16 v[188:191], a[212:215], a[180:183], v[188:191]
    s_max_i32 s82, s82, 0
    v_exp_f32 v185, v185
    v_mfma_f32_16x16x32_bf16 v[188:191], a[216:219], a[184:187], v[188:191]
    ds_read_b64_tr_b16 a[228:229], v203 offset:16384
    v_add_f32 v196, v196, v184
    v_mfma_f32_16x16x32_bf16 v[188:191], a[220:223], a[188:191], v[188:191]
    buffer_load_dwordx4 v214, s[84:87], 0 offen offset:2048 nt lds
    v_exp_f32 v186, v186
    v_mfma_f32_16x16x32_bf16 v[96:99], a[236:239], v[168:171], v[96:99]
    ds_read_b64_tr_b16 a[230:231], v203 offset:20480
    v_cvt_pk_bf16_f32 v154, v184, v185
    v_mfma_f32_16x16x32_bf16 v[100:103], a[236:239], v[172:175], v[100:103]
    buffer_load_dwordx4 v215, s[84:87], 0 offen offset:3072 nt lds
    v_exp_f32 v187, v187
    v_mfma_f32_16x16x32_bf16 v[104:107], a[236:239], v[176:179], v[104:107]
    s_add_u32 s84, s84, 16384
    v_add_f32 v196, v196, v185
    v_add_f32 v196, v196, v186
    v_mfma_f32_16x16x32_bf16 v[108:111], a[236:239], v[180:183], v[108:111]
    s_addc_u32 s85, s85, 0
    s_sub_i32 s86, s86, 16384
    s_max_i32 s86, s86, 0
    v_add_f32 v196, v196, v187
    v_cvt_pk_bf16_f32 v155, v186, v187
.p2align 6
L_loop:
    v_mfma_f32_16x16x32_bf16 v[184:187], a[192:195], a[96:99], v[112:115]
    v_exp_f32 v188, v188
    v_mfma_f32_16x16x32_bf16 v[184:187], a[196:199], a[100:103], v[184:187]
    v_exp_f32 v189, v189
    v_mfma_f32_16x16x32_bf16 v[184:187], a[200:203], a[104:107], v[184:187]
    ds_read_b64_tr_b16 a[232:233], v204 offset:16384
    v_add_f32 v197, v197, v188
    v_mfma_f32_16x16x32_bf16 v[184:187], a[204:207], a[108:111], v[184:187]
    s_waitcnt lgkmcnt(3)
    v_exp_f32 v190, v190
    v_mfma_f32_16x16x32_bf16 a[0:3], a[224:227], v[136:139], a[0:3]
    ds_read_b64_tr_b16 a[234:235], v204 offset:20480
    v_cvt_pk_bf16_f32 v158, v188, v189
    v_mfma_f32_16x16x32_bf16 a[4:7], a[224:227], v[140:143], a[4:7]
    v_exp_f32 v191, v191
    v_mfma_f32_16x16x32_bf16 a[8:11], a[224:227], v[144:147], a[8:11]
    v_add_f32 v197, v197, v189
    v_add_f32 v197, v197, v190
    v_mfma_f32_16x16x32_bf16 a[12:15], a[224:227], v[148:151], a[12:15]
    v_add_f32 v197, v197, v191
    v_cvt_pk_bf16_f32 v159, v190, v191
    v_mfma_f32_16x16x32_bf16 v[188:191], a[192:195], a[112:115], v[116:119]
    v_exp_f32 v184, v184
    v_mfma_f32_16x16x32_bf16 v[188:191], a[196:199], a[116:119], v[188:191]
    s_mov_b32 m0, s88
    v_exp_f32 v185, v185
    v_mfma_f32_16x16x32_bf16 v[188:191], a[200:203], a[120:123], v[188:191]
    ds_read_b64_tr_b16 a[236:237], v205 offset:16384
    v_add_f32 v192, v192, v184
    v_mfma_f32_16x16x32_bf16 v[188:191], a[204:207], a[124:127], v[188:191]
    buffer_load_dwordx4 v210, s[80:83], 0 offen nt lds
    v_exp_f32 v186, v186
    v_mfma_f32_16x16x32_bf16 a[16:19], a[224:227], v[152:155], a[16:19]
    ds_read_b64_tr_b16 a[238:239], v205 offset:20480
    v_cvt_pk_bf16_f32 v160, v184, v185
    v_mfma_f32_16x16x32_bf16 a[20:23], a[224:227], v[156:159], a[20:23]
    s_waitcnt lgkmcnt(4)
    v_exp_f32 v187, v187
    v_mfma_f32_16x16x32_bf16 a[24:27], a[228:231], v[136:139], a[24:27]
    v_add_f32 v192, v192, v185
    v_add_f32 v192, v192, v186
    v_mfma_f32_16x16x32_bf16 a[28:31], a[228:231], v[140:143], a[28:31]
    v_add_f32 v192, v192, v187
    v_cvt_pk_bf16_f32 v161, v186, v187
    v_mfma_f32_16x16x32_bf16 v[184:187], a[192:195], a[128:131], v[120:123]
    v_exp_f32 v188, v188
    v_mfma_f32_16x16x32_bf16 v[184:187], a[196:199], a[132:135], v[184:187]
    v_exp_f32 v189, v189
    v_mfma_f32_16x16x32_bf16 v[184:187], a[200:203], a[136:139], v[184:187]
    ds_read_b128 a[208:211], v198 offset:16384
    v_add_f32 v193, v193, v188
    v_mfma_f32_16x16x32_bf16 v[184:187], a[204:207], a[140:143], v[184:187]
    v_exp_f32 v190, v190
    v_mfma_f32_16x16x32_bf16 a[32:35], a[228:231], v[144:147], a[32:35]
    ds_read_b128 a[212:215], v199 offset:16384
    v_cvt_pk_bf16_f32 v164, v188, v189
    v_mfma_f32_16x16x32_bf16 a[36:39], a[228:231], v[148:151], a[36:39]
    v_exp_f32 v191, v191
    v_mfma_f32_16x16x32_bf16 a[40:43], a[228:231], v[152:155], a[40:43]
    v_add_f32 v193, v193, v189
    v_add_f32 v193, v193, v190
    v_mfma_f32_16x16x32_bf16 a[44:47], a[228:231], v[156:159], a[44:47]
    v_add_f32 v193, v193, v191
    v_cvt_pk_bf16_f32 v165, v190, v191
    v_mfma_f32_16x16x32_bf16 v[188:191], a[192:195], a[144:147], v[124:127]
    v_exp_f32 v184, v184
    v_mfma_f32_16x16x32_bf16 v[188:191], a[196:199], a[148:151], v[188:191]
    v_exp_f32 v185, v185
    v_mfma_f32_16x16x32_bf16 v[188:191], a[200:203], a[152:155], v[188:191]
    ds_read_b64_tr_b16 a[224:225], v206 offset:16384
    v_add_f32 v194, v194, v184
    v_mfma_f32_16x16x32_bf16 v[188:191], a[204:207], a[156:159], v[188:191]
    s_waitcnt lgkmcnt(5)
    v_exp_f32 v186, v186
    v_mfma_f32_16x16x32_bf16 a[48:51], a[232:235], v[136:139], a[48:51]
    ds_read_b64_tr_b16 a[226:227], v206 offset:20480
    v_cvt_pk_bf16_f32 v168, v184, v185
    v_mfma_f32_16x16x32_bf16 a[52:55], a[232:235], v[140:143], a[52:55]
    v_exp_f32 v187, v187
    v_mfma_f32_16x16x32_bf16 a[56:59], a[232:235], v[144:147], a[56:59]
    v_add_f32 v194, v194, v185
    v_add_f32 v194, v194, v186
    v_mfma_f32_16x16x32_bf16 a[60:63], a[232:235], v[148:151], a[60:63]
    v_add_f32 v194, v194, v187
    v_cvt_pk_bf16_f32 v169, v186, v187
    v_mfma_f32_16x16x32_bf16 v[184:187], a[192:195], a[160:163], v[128:131]
    v_exp_f32 v188, v188
    v_mfma_f32_16x16x32_bf16 v[184:187], a[196:199], a[164:167], v[184:187]
    v_exp_f32 v189, v189
    v_mfma_f32_16x16x32_bf16 v[184:187], a[200:203], a[168:171], v[184:187]
    ds_read_b128 a[216:219], v200 offset:16384
    v_add_f32 v195, v195, v188
    v_mfma_f32_16x16x32_bf16 v[184:187], a[204:207], a[172:175], v[184:187]
    buffer_load_dwordx4 v211, s[80:83], 0 offen offset:1024 nt lds
    v_exp_f32 v190, v190
    v_mfma_f32_16x16x32_bf16 a[64:67], a[232:235], v[152:155], a[64:67]
    ds_read_b128 a[220:223], v201 offset:16384
    v_cvt_pk_bf16_f32 v172, v188, v189
    v_mfma_f32_16x16x32_bf16 a[68:71], a[232:235], v[156:159], a[68:71]
    s_waitcnt lgkmcnt(6)
    v_exp_f32 v191, v191
    v_mfma_f32_16x16x32_bf16 a[72:75], a[236:239], v[136:139], a[72:75]
    v_add_f32 v195, v195, v189
    v_add_f32 v195, v195, v190
    v_mfma_f32_16x16x32_bf16 a[76:79], a[236:239], v[140:143], a[76:79]
    v_add_f32 v195, v195, v191
    v_cvt_pk_bf16_f32 v173, v190, v191
    v_mfma_f32_16x16x32_bf16 v[188:191], a[192:195], a[176:179], v[132:135]
    v_exp_f32 v184, v184
    v_mfma_f32_16x16x32_bf16 v[188:191], a[196:199], a[180:183], v[188:191]
    v_exp_f32 v185, v185
    v_mfma_f32_16x16x32_bf16 v[188:191], a[200:203], a[184:187], v[188:191]
    ds_read_b64_tr_b16 a[228:229], v207 offset:16384
    v_add_f32 v196, v196, v184
    v_mfma_f32_16x16x32_bf16 v[188:191], a[204:207], a[188:191], v[188:191]
    v_exp_f32 v186, v186
    v_mfma_f32_16x16x32_bf16 a[80:83], a[236:239], v[144:147], a[80:83]
    ds_read_b64_tr_b16 a[230:231], v207 offset:20480
    v_cvt_pk_bf16_f32 v176, v184, v185
    v_mfma_f32_16x16x32_bf16 a[84:87], a[236:239], v[148:151], a[84:87]
    v_exp_f32 v187, v187
    v_mfma_f32_16x16x32_bf16 a[88:91], a[236:239], v[152:155], a[88:91]
    v_add_f32 v196, v196, v185
    v_add_f32 v196, v196, v186
    v_mfma_f32_16x16x32_bf16 a[92:95], a[236:239], v[156:159], a[92:95]
    s_waitcnt lgkmcnt(2)
    v_add_f32 v196, v196, v187
    v_cvt_pk_bf16_f32 v177, v186, v187
    v_mfma_f32_16x16x32_bf16 v[184:187], a[208:211], a[96:99], v[112:115]
    v_exp_f32 v188, v188
    v_mfma_f32_16x16x32_bf16 v[184:187], a[212:215], a[100:103], v[184:187]
    v_exp_f32 v189, v189
    v_mfma_f32_16x16x32_bf16 v[184:187], a[216:219], a[104:107], v[184:187]
    ds_read_b64_tr_b16 a[232:233], v208 offset:16384
    v_add_f32 v197, v197, v188
    v_mfma_f32_16x16x32_bf16 v[184:187], a[220:223], a[108:111], v[184:187]
    v_exp_f32 v190, v190
    v_mfma_f32_16x16x32_bf16 v[16:19], a[224:227], v[136:139], v[16:19]
    ds_read_b64_tr_b16 a[234:235], v208 offset:20480
    v_cvt_pk_bf16_f32 v180, v188, v189
    v_mfma_f32_16x16x32_bf16 v[20:23], a[224:227], v[140:143], v[20:23]
    v_exp_f32 v191, v191
    v_mfma_f32_16x16x32_bf16 v[24:27], a[224:227], v[144:147], v[24:27]
    v_add_f32 v197, v197, v189
    v_add_f32 v197, v197, v190
    v_mfma_f32_16x16x32_bf16 v[28:31], a[224:227], v[148:151], v[28:31]
    v_add_f32 v197, v197, v191
    v_cvt_pk_bf16_f32 v181, v190, v191
    v_mfma_f32_16x16x32_bf16 v[188:191], a[208:211], a[112:115], v[116:119]
    v_exp_f32 v184, v184
    v_mfma_f32_16x16x32_bf16 v[188:191], a[212:215], a[116:119], v[188:191]
    v_exp_f32 v185, v185
    v_mfma_f32_16x16x32_bf16 v[188:191], a[216:219], a[120:123], v[188:191]
    ds_read_b64_tr_b16 a[236:237], v209 offset:16384
    v_add_f32 v192, v192, v184
    v_mfma_f32_16x16x32_bf16 v[188:191], a[220:223], a[124:127], v[188:191]
    buffer_load_dwordx4 v212, s[80:83], 0 offen offset:2048 nt lds
    v_exp_f32 v186, v186
    v_mfma_f32_16x16x32_bf16 v[32:35], a[224:227], v[152:155], v[32:35]
    ds_read_b64_tr_b16 a[238:239], v209 offset:20480
    v_cvt_pk_bf16_f32 v162, v184, v185
    v_mfma_f32_16x16x32_bf16 v[36:39], a[224:227], v[156:159], v[36:39]
    s_waitcnt lgkmcnt(4)
    v_exp_f32 v187, v187
    v_mfma_f32_16x16x32_bf16 v[40:43], a[228:231], v[136:139], v[40:43]
    v_add_f32 v192, v192, v185
    v_add_f32 v192, v192, v186
    v_mfma_f32_16x16x32_bf16 v[44:47], a[228:231], v[140:143], v[44:47]
    v_add_f32 v192, v192, v187
    v_cvt_pk_bf16_f32 v163, v186, v187
    v_mfma_f32_16x16x32_bf16 v[184:187], a[208:211], a[128:131], v[120:123]
    v_exp_f32 v188, v188
    v_mfma_f32_16x16x32_bf16 v[184:187], a[212:215], a[132:135], v[184:187]
    v_exp_f32 v189, v189
    v_mfma_f32_16x16x32_bf16 v[184:187], a[216:219], a[136:139], v[184:187]
    ds_read_b128 a[192:195], v198 offset:20480
    v_add_f32 v193, v193, v188
    v_mfma_f32_16x16x32_bf16 v[184:187], a[220:223], a[140:143], v[184:187]
    v_exp_f32 v190, v190
    v_mfma_f32_16x16x32_bf16 v[48:51], a[228:231], v[144:147], v[48:51]
    ds_read_b128 a[196:199], v199 offset:20480
    v_cvt_pk_bf16_f32 v166, v188, v189
    v_mfma_f32_16x16x32_bf16 v[52:55], a[228:231], v[148:151], v[52:55]
    v_exp_f32 v191, v191
    v_mfma_f32_16x16x32_bf16 v[56:59], a[228:231], v[152:155], v[56:59]
    v_add_f32 v193, v193, v189
    v_add_f32 v193, v193, v190
    v_mfma_f32_16x16x32_bf16 v[60:63], a[228:231], v[156:159], v[60:63]
    v_add_f32 v193, v193, v191
    v_cvt_pk_bf16_f32 v167, v190, v191
    v_mfma_f32_16x16x32_bf16 v[188:191], a[208:211], a[144:147], v[124:127]
    v_exp_f32 v184, v184
    v_mfma_f32_16x16x32_bf16 v[188:191], a[212:215], a[148:151], v[188:191]
    v_exp_f32 v185, v185
    v_mfma_f32_16x16x32_bf16 v[188:191], a[216:219], a[152:155], v[188:191]
    ds_read_b128 a[200:203], v200 offset:20480
    v_add_f32 v194, v194, v184
    v_mfma_f32_16x16x32_bf16 v[188:191], a[220:223], a[156:159], v[188:191]
    s_waitcnt lgkmcnt(5)
    v_exp_f32 v186, v186
    v_mfma_f32_16x16x32_bf16 v[64:67], a[232:235], v[136:139], v[64:67]
    ds_read_b128 a[204:207], v201 offset:20480
    v_cvt_pk_bf16_f32 v170, v184, v185
    v_mfma_f32_16x16x32_bf16 v[68:71], a[232:235], v[140:143], v[68:71]
    v_exp_f32 v187, v187
    v_mfma_f32_16x16x32_bf16 v[72:75], a[232:235], v[144:147], v[72:75]
    v_add_f32 v194, v194, v185
    v_add_f32 v194, v194, v186
    v_mfma_f32_16x16x32_bf16 v[76:79], a[232:235], v[148:151], v[76:79]
    v_add_f32 v194, v194, v187
    v_cvt_pk_bf16_f32 v171, v186, v187
    v_mfma_f32_16x16x32_bf16 v[184:187], a[208:211], a[160:163], v[128:131]
    v_exp_f32 v188, v188
    v_mfma_f32_16x16x32_bf16 v[184:187], a[212:215], a[164:167], v[184:187]
    v_exp_f32 v189, v189
    v_mfma_f32_16x16x32_bf16 v[184:187], a[216:219], a[168:171], v[184:187]
    ds_read_b64_tr_b16 a[224:225], v202 offset:24576
    v_add_f32 v195, v195, v188
    v_mfma_f32_16x16x32_bf16 v[184:187], a[220:223], a[172:175], v[184:187]
    buffer_load_dwordx4 v213, s[80:83], 0 offen offset:3072 nt lds
    v_exp_f32 v190, v190
    v_mfma_f32_16x16x32_bf16 v[80:83], a[232:235], v[152:155], v[80:83]
    ds_read_b64_tr_b16 a[226:227], v202 offset:28672
    v_cvt_pk_bf16_f32 v174, v188, v189
    v_mfma_f32_16x16x32_bf16 v[84:87], a[232:235], v[156:159], v[84:87]
    s_waitcnt lgkmcnt(6)
    v_exp_f32 v191, v191
    v_mfma_f32_16x16x32_bf16 v[88:91], a[236:239], v[136:139], v[88:91]
    s_add_u32 s80, s80, 16384
    v_add_f32 v195, v195, v189
    v_add_f32 v195, v195, v190
    v_mfma_f32_16x16x32_bf16 v[92:95], a[236:239], v[140:143], v[92:95]
    s_addc_u32 s81, s81, 0
    v_add_f32 v195, v195, v191
    v_cvt_pk_bf16_f32 v175, v190, v191
    v_mfma_f32_16x16x32_bf16 v[188:191], a[208:211], a[176:179], v[132:135]
    s_sub_i32 s82, s82, 16384
    v_exp_f32 v184, v184
    v_mfma_f32_16x16x32_bf16 v[188:191], a[212:215], a[180:183], v[188:191]
    s_max_i32 s82, s82, 0
    v_exp_f32 v185, v185
    v_mfma_f32_16x16x32_bf16 v[188:191], a[216:219], a[184:187], v[188:191]
    ds_read_b64_tr_b16 a[228:229], v203 offset:24576
    v_add_f32 v196, v196, v184
    v_mfma_f32_16x16x32_bf16 v[188:191], a[220:223], a[188:191], v[188:191]
    v_exp_f32 v186, v186
    v_mfma_f32_16x16x32_bf16 v[96:99], a[236:239], v[144:147], v[96:99]
    ds_read_b64_tr_b16 a[230:231], v203 offset:28672
    v_cvt_pk_bf16_f32 v178, v184, v185
    v_mfma_f32_16x16x32_bf16 v[100:103], a[236:239], v[148:151], v[100:103]
    v_exp_f32 v187, v187
    v_mfma_f32_16x16x32_bf16 v[104:107], a[236:239], v[152:155], v[104:107]
    v_add_f32 v196, v196, v185
    v_add_f32 v196, v196, v186
    v_mfma_f32_16x16x32_bf16 v[108:111], a[236:239], v[156:159], v[108:111]
    s_waitcnt lgkmcnt(4)
    v_add_f32 v196, v196, v187
    v_cvt_pk_bf16_f32 v179, v186, v187
    v_mfma_f32_16x16x32_bf16 v[184:187], a[192:195], a[96:99], v[112:115]
    v_exp_f32 v188, v188
    v_mfma_f32_16x16x32_bf16 v[184:187], a[196:199], a[100:103], v[184:187]
    v_exp_f32 v189, v189
    v_mfma_f32_16x16x32_bf16 v[184:187], a[200:203], a[104:107], v[184:187]
    ds_read_b64_tr_b16 a[232:233], v204 offset:24576
    v_add_f32 v197, v197, v188
    v_mfma_f32_16x16x32_bf16 v[184:187], a[204:207], a[108:111], v[184:187]
    s_waitcnt lgkmcnt(3)
    v_exp_f32 v190, v190
    v_mfma_f32_16x16x32_bf16 a[0:3], a[224:227], v[160:163], a[0:3]
    ds_read_b64_tr_b16 a[234:235], v204 offset:28672
    v_cvt_pk_bf16_f32 v182, v188, v189
    v_mfma_f32_16x16x32_bf16 a[4:7], a[224:227], v[164:167], a[4:7]
    v_exp_f32 v191, v191
    v_mfma_f32_16x16x32_bf16 a[8:11], a[224:227], v[168:171], a[8:11]
    v_add_f32 v197, v197, v189
    v_add_f32 v197, v197, v190
    v_mfma_f32_16x16x32_bf16 a[12:15], a[224:227], v[172:175], a[12:15]
    v_add_f32 v197, v197, v191
    v_cvt_pk_bf16_f32 v183, v190, v191
    v_mfma_f32_16x16x32_bf16 v[188:191], a[192:195], a[112:115], v[116:119]
    v_exp_f32 v184, v184
    v_mfma_f32_16x16x32_bf16 v[188:191], a[196:199], a[116:119], v[188:191]
    s_mov_b32 m0, s92
    v_exp_f32 v185, v185
    v_mfma_f32_16x16x32_bf16 v[188:191], a[200:203], a[120:123], v[188:191]
    ds_read_b64_tr_b16 a[236:237], v205 offset:24576
    v_add_f32 v192, v192, v184
    v_mfma_f32_16x16x32_bf16 v[188:191], a[204:207], a[124:127], v[188:191]
    buffer_load_dwordx4 v214, s[84:87], 0 offen nt lds
    v_exp_f32 v186, v186
    v_mfma_f32_16x16x32_bf16 a[16:19], a[224:227], v[176:179], a[16:19]
    ds_read_b64_tr_b16 a[238:239], v205 offset:28672
    v_cvt_pk_bf16_f32 v136, v184, v185
    v_mfma_f32_16x16x32_bf16 a[20:23], a[224:227], v[180:183], a[20:23]
    s_waitcnt lgkmcnt(4)
    v_exp_f32 v187, v187
    v_mfma_f32_16x16x32_bf16 a[24:27], a[228:231], v[160:163], a[24:27]
    v_add_f32 v192, v192, v185
    v_add_f32 v192, v192, v186
    v_mfma_f32_16x16x32_bf16 a[28:31], a[228:231], v[164:167], a[28:31]
    v_add_f32 v192, v192, v187
    v_cvt_pk_bf16_f32 v137, v186, v187
    v_mfma_f32_16x16x32_bf16 v[184:187], a[192:195], a[128:131], v[120:123]
    v_exp_f32 v188, v188
    v_mfma_f32_16x16x32_bf16 v[184:187], a[196:199], a[132:135], v[184:187]
    v_exp_f32 v189, v189
    v_mfma_f32_16x16x32_bf16 v[184:187], a[200:203], a[136:139], v[184:187]
    ds_read_b128 a[208:211], v198 offset:24576
    v_add_f32 v193, v193, v188
    v_mfma_f32_16x16x32_bf16 v[184:187], a[204:207], a[140:143], v[184:187]
    v_exp_f32 v190, v190
    v_mfma_f32_16x16x32_bf16 a[32:35], a[228:231], v[168:171], a[32:35]
    ds_read_b128 a[212:215], v199 offset:24576
    v_cvt_pk_bf16_f32 v140, v188, v189
    v_mfma_f32_16x16x32_bf16 a[36:39], a[228:231], v[172:175], a[36:39]
    v_exp_f32 v191, v191
    v_mfma_f32_16x16x32_bf16 a[40:43], a[228:231], v[176:179], a[40:43]
    v_add_f32 v193, v193, v189
    v_add_f32 v193, v193, v190
    v_mfma_f32_16x16x32_bf16 a[44:47], a[228:231], v[180:183], a[44:47]
    v_add_f32 v193, v193, v191
    v_cvt_pk_bf16_f32 v141, v190, v191
    v_mfma_f32_16x16x32_bf16 v[188:191], a[192:195], a[144:147], v[124:127]
    v_exp_f32 v184, v184
    v_mfma_f32_16x16x32_bf16 v[188:191], a[196:199], a[148:151], v[188:191]
    v_exp_f32 v185, v185
    v_mfma_f32_16x16x32_bf16 v[188:191], a[200:203], a[152:155], v[188:191]
    ds_read_b64_tr_b16 a[224:225], v206 offset:24576
    v_add_f32 v194, v194, v184
    v_mfma_f32_16x16x32_bf16 v[188:191], a[204:207], a[156:159], v[188:191]
    s_waitcnt lgkmcnt(5)
    v_exp_f32 v186, v186
    v_mfma_f32_16x16x32_bf16 a[48:51], a[232:235], v[160:163], a[48:51]
    ds_read_b64_tr_b16 a[226:227], v206 offset:28672
    v_cvt_pk_bf16_f32 v144, v184, v185
    v_mfma_f32_16x16x32_bf16 a[52:55], a[232:235], v[164:167], a[52:55]
    v_exp_f32 v187, v187
    v_mfma_f32_16x16x32_bf16 a[56:59], a[232:235], v[168:171], a[56:59]
    v_add_f32 v194, v194, v185
    v_add_f32 v194, v194, v186
    v_mfma_f32_16x16x32_bf16 a[60:63], a[232:235], v[172:175], a[60:63]
    v_add_f32 v194, v194, v187
    v_cvt_pk_bf16_f32 v145, v186, v187
    v_mfma_f32_16x16x32_bf16 v[184:187], a[192:195], a[160:163], v[128:131]
    v_exp_f32 v188, v188
    v_mfma_f32_16x16x32_bf16 v[184:187], a[196:199], a[164:167], v[184:187]
    v_exp_f32 v189, v189
    v_mfma_f32_16x16x32_bf16 v[184:187], a[200:203], a[168:171], v[184:187]
    ds_read_b128 a[216:219], v200 offset:24576
    v_add_f32 v195, v195, v188
    v_mfma_f32_16x16x32_bf16 v[184:187], a[204:207], a[172:175], v[184:187]
    buffer_load_dwordx4 v215, s[84:87], 0 offen offset:1024 nt lds
    v_exp_f32 v190, v190
    v_mfma_f32_16x16x32_bf16 a[64:67], a[232:235], v[176:179], a[64:67]
    ds_read_b128 a[220:223], v201 offset:24576
    v_cvt_pk_bf16_f32 v148, v188, v189
    v_mfma_f32_16x16x32_bf16 a[68:71], a[232:235], v[180:183], a[68:71]
    s_waitcnt lgkmcnt(6)
    v_exp_f32 v191, v191
    v_mfma_f32_16x16x32_bf16 a[72:75], a[236:239], v[160:163], a[72:75]
    v_add_f32 v195, v195, v189
    v_add_f32 v195, v195, v190
    v_mfma_f32_16x16x32_bf16 a[76:79], a[236:239], v[164:167], a[76:79]
    v_add_f32 v195, v195, v191
    v_cvt_pk_bf16_f32 v149, v190, v191
    v_mfma_f32_16x16x32_bf16 v[188:191], a[192:195], a[176:179], v[132:135]
    v_exp_f32 v184, v184
    v_mfma_f32_16x16x32_bf16 v[188:191], a[196:199], a[180:183], v[188:191]
    v_exp_f32 v185, v185
    v_mfma_f32_16x16x32_bf16 v[188:191], a[200:203], a[184:187], v[188:191]
    ds_read_b64_tr_b16 a[228:229], v207 offset:24576
    v_add_f32 v196, v196, v184
    v_mfma_f32_16x16x32_bf16 v[188:191], a[204:207], a[188:191], v[188:191]
    v_exp_f32 v186, v186
    v_mfma_f32_16x16x32_bf16 a[80:83], a[236:239], v[168:171], a[80:83]
    ds_read_b64_tr_b16 a[230:231], v207 offset:28672
    v_cvt_pk_bf16_f32 v152, v184, v185
    v_mfma_f32_16x16x32_bf16 a[84:87], a[236:239], v[172:175], a[84:87]
    v_exp_f32 v187, v187
    v_mfma_f32_16x16x32_bf16 a[88:91], a[236:239], v[176:179], a[88:91]
    v_add_f32 v196, v196, v185
    v_add_f32 v196, v196, v186
    v_mfma_f32_16x16x32_bf16 a[92:95], a[236:239], v[180:183], a[92:95]
    s_waitcnt lgkmcnt(2)
    v_add_f32 v196, v196, v187
    v_cvt_pk_bf16_f32 v153, v186, v187
    v_mfma_f32_16x16x32_bf16 v[184:187], a[208:211], a[96:99], v[112:115]
    v_exp_f32 v188, v188
    v_mfma_f32_16x16x32_bf16 v[184:187], a[212:215], a[100:103], v[184:187]
    v_exp_f32 v189, v189
    v_mfma_f32_16x16x32_bf16 v[184:187], a[216:219], a[104:107], v[184:187]
    ds_read_b64_tr_b16 a[232:233], v208 offset:24576
    v_add_f32 v197, v197, v188
    v_mfma_f32_16x16x32_bf16 v[184:187], a[220:223], a[108:111], v[184:187]
    v_exp_f32 v190, v190
    v_mfma_f32_16x16x32_bf16 v[16:19], a[224:227], v[160:163], v[16:19]
    ds_read_b64_tr_b16 a[234:235], v208 offset:28672
    v_cvt_pk_bf16_f32 v156, v188, v189
    v_mfma_f32_16x16x32_bf16 v[20:23], a[224:227], v[164:167], v[20:23]
    v_exp_f32 v191, v191
    v_mfma_f32_16x16x32_bf16 v[24:27], a[224:227], v[168:171], v[24:27]
    v_add_f32 v197, v197, v189
    v_add_f32 v197, v197, v190
    v_mfma_f32_16x16x32_bf16 v[28:31], a[224:227], v[172:175], v[28:31]
    v_add_f32 v197, v197, v191
    v_cvt_pk_bf16_f32 v157, v190, v191
    v_mfma_f32_16x16x32_bf16 v[188:191], a[208:211], a[112:115], v[116:119]
    v_exp_f32 v184, v184
    v_mfma_f32_16x16x32_bf16 v[188:191], a[212:215], a[116:119], v[188:191]
    v_exp_f32 v185, v185
    v_mfma_f32_16x16x32_bf16 v[188:191], a[216:219], a[120:123], v[188:191]
    ds_read_b64_tr_b16 a[236:237], v209 offset:24576
    v_add_f32 v192, v192, v184
    v_mfma_f32_16x16x32_bf16 v[188:191], a[220:223], a[124:127], v[188:191]
    buffer_load_dwordx4 v214, s[84:87], 0 offen offset:2048 nt lds
    v_exp_f32 v186, v186
    v_mfma_f32_16x16x32_bf16 v[32:35], a[224:227], v[176:179], v[32:35]
    ds_read_b64_tr_b16 a[238:239], v209 offset:28672
    v_cvt_pk_bf16_f32 v138, v184, v185
    v_mfma_f32_16x16x32_bf16 v[36:39], a[224:227], v[180:183], v[36:39]
    s_waitcnt lgkmcnt(4)
    v_exp_f32 v187, v187
    v_mfma_f32_16x16x32_bf16 v[40:43], a[228:231], v[160:163], v[40:43]
    v_add_f32 v192, v192, v185
    v_add_f32 v192, v192, v186
    v_mfma_f32_16x16x32_bf16 v[44:47], a[228:231], v[164:167], v[44:47]
    v_add_f32 v192, v192, v187
    v_cvt_pk_bf16_f32 v139, v186, v187
    v_mfma_f32_16x16x32_bf16 v[184:187], a[208:211], a[128:131], v[120:123]
    v_exp_f32 v188, v188
    v_mfma_f32_16x16x32_bf16 v[184:187], a[212:215], a[132:135], v[184:187]
    v_exp_f32 v189, v189
    v_mfma_f32_16x16x32_bf16 v[184:187], a[216:219], a[136:139], v[184:187]
    ds_read_b128 a[192:195], v198 offset:28672
    v_add_f32 v193, v193, v188
    v_mfma_f32_16x16x32_bf16 v[184:187], a[220:223], a[140:143], v[184:187]
    buffer_load_dwordx4 v215, s[84:87], 0 offen offset:3072 nt lds
    v_exp_f32 v190, v190
    v_mfma_f32_16x16x32_bf16 v[48:51], a[228:231], v[168:171], v[48:51]
    ds_read_b128 a[196:199], v199 offset:28672
    v_cvt_pk_bf16_f32 v142, v188, v189
    v_mfma_f32_16x16x32_bf16 v[52:55], a[228:231], v[172:175], v[52:55]
    s_add_u32 s84, s84, 16384
    v_exp_f32 v191, v191
    v_mfma_f32_16x16x32_bf16 v[56:59], a[228:231], v[176:179], v[56:59]
    s_addc_u32 s85, s85, 0
    v_add_f32 v193, v193, v189
    v_add_f32 v193, v193, v190
    v_mfma_f32_16x16x32_bf16 v[60:63], a[228:231], v[180:183], v[60:63]
    s_sub_i32 s86, s86, 16384
    v_add_f32 v193, v193, v191
    v_cvt_pk_bf16_f32 v143, v190, v191
    v_mfma_f32_16x16x32_bf16 v[188:191], a[208:211], a[144:147], v[124:127]
    s_max_i32 s86, s86, 0
    v_exp_f32 v184, v184
    v_mfma_f32_16x16x32_bf16 v[188:191], a[212:215], a[148:151], v[188:191]
    v_exp_f32 v185, v185
    v_mfma_f32_16x16x32_bf16 v[188:191], a[216:219], a[152:155], v[188:191]
    ds_read_b128 a[200:203], v200 offset:28672
    v_add_f32 v194, v194, v184
    v_mfma_f32_16x16x32_bf16 v[188:191], a[220:223], a[156:159], v[188:191]
    s_waitcnt lgkmcnt(5)
    v_exp_f32 v186, v186
    v_mfma_f32_16x16x32_bf16 v[64:67], a[232:235], v[160:163], v[64:67]
    ds_read_b128 a[204:207], v201 offset:28672
    v_cvt_pk_bf16_f32 v146, v184, v185
    v_mfma_f32_16x16x32_bf16 v[68:71], a[232:235], v[164:167], v[68:71]
    v_exp_f32 v187, v187
    v_mfma_f32_16x16x32_bf16 v[72:75], a[232:235], v[168:171], v[72:75]
    v_add_f32 v194, v194, v185
    v_add_f32 v194, v194, v186
    v_mfma_f32_16x16x32_bf16 v[76:79], a[232:235], v[172:175], v[76:79]
    v_add_f32 v194, v194, v187
    v_cvt_pk_bf16_f32 v147, v186, v187
    v_mfma_f32_16x16x32_bf16 v[184:187], a[208:211], a[160:163], v[128:131]
    s_waitcnt vmcnt(16) lgkmcnt(0)
    v_exp_f32 v188, v188
    v_mfma_f32_16x16x32_bf16 v[184:187], a[212:215], a[164:167], v[184:187]
    s_barrier
    v_exp_f32 v189, v189
    v_mfma_f32_16x16x32_bf16 v[184:187], a[216:219], a[168:171], v[184:187]
    ds_read_b64_tr_b16 a[224:225], v202 offset:32768
    v_add_f32 v195, v195, v188
    v_mfma_f32_16x16x32_bf16 v[184:187], a[220:223], a[172:175], v[184:187]
    v_exp_f32 v190, v190
    v_mfma_f32_16x16x32_bf16 v[80:83], a[232:235], v[176:179], v[80:83]
    ds_read_b64_tr_b16 a[226:227], v202 offset:36864
    v_cvt_pk_bf16_f32 v150, v188, v189
    v_mfma_f32_16x16x32_bf16 v[84:87], a[232:235], v[180:183], v[84:87]
    v_exp_f32 v191, v191
    v_mfma_f32_16x16x32_bf16 v[88:91], a[236:239], v[160:163], v[88:91]
    v_add_f32 v195, v195, v189
    v_add_f32 v195, v195, v190
    v_mfma_f32_16x16x32_bf16 v[92:95], a[236:239], v[164:167], v[92:95]
    v_add_f32 v195, v195, v191
    v_cvt_pk_bf16_f32 v151, v190, v191
    v_mfma_f32_16x16x32_bf16 v[188:191], a[208:211], a[176:179], v[132:135]
    v_exp_f32 v184, v184
    v_mfma_f32_16x16x32_bf16 v[188:191], a[212:215], a[180:183], v[188:191]
    v_exp_f32 v185, v185
    v_mfma_f32_16x16x32_bf16 v[188:191], a[216:219], a[184:187], v[188:191]
    ds_read_b64_tr_b16 a[228:229], v203 offset:32768
    v_add_f32 v196, v196, v184
    v_mfma_f32_16x16x32_bf16 v[188:191], a[220:223], a[188:191], v[188:191]
    v_exp_f32 v186, v186
    v_mfma_f32_16x16x32_bf16 v[96:99], a[236:239], v[168:171], v[96:99]
    ds_read_b64_tr_b16 a[230:231], v203 offset:36864
    v_cvt_pk_bf16_f32 v154, v184, v185
    v_mfma_f32_16x16x32_bf16 v[100:103], a[236:239], v[172:175], v[100:103]
    v_exp_f32 v187, v187
    v_mfma_f32_16x16x32_bf16 v[104:107], a[236:239], v[176:179], v[104:107]
    v_add_f32 v196, v196, v185
    v_add_f32 v196, v196, v186
    v_mfma_f32_16x16x32_bf16 v[108:111], a[236:239], v[180:183], v[108:111]
    v_add_f32 v196, v196, v187
    v_cvt_pk_bf16_f32 v155, v186, v187
    v_mfma_f32_16x16x32_bf16 v[184:187], a[192:195], a[96:99], v[112:115]
    v_exp_f32 v188, v188
    v_mfma_f32_16x16x32_bf16 v[184:187], a[196:199], a[100:103], v[184:187]
    v_exp_f32 v189, v189
    v_mfma_f32_16x16x32_bf16 v[184:187], a[200:203], a[104:107], v[184:187]
    ds_read_b64_tr_b16 a[232:233], v204 offset:32768
    v_add_f32 v197, v197, v188
    v_mfma_f32_16x16x32_bf16 v[184:187], a[204:207], a[108:111], v[184:187]
    s_waitcnt lgkmcnt(3)
    v_exp_f32 v190, v190
    v_mfma_f32_16x16x32_bf16 a[0:3], a[224:227], v[136:139], a[0:3]
    ds_read_b64_tr_b16 a[234:235], v204 offset:36864
    v_cvt_pk_bf16_f32 v158, v188, v189
    v_mfma_f32_16x16x32_bf16 a[4:7], a[224:227], v[140:143], a[4:7]
    v_exp_f32 v191, v191
    v_mfma_f32_16x16x32_bf16 a[8:11], a[224:227], v[144:147], a[8:11]
    v_add_f32 v197, v197, v189
    v_add_f32 v197, v197, v190
    v_mfma_f32_16x16x32_bf16 a[12:15], a[224:227], v[148:151], a[12:15]
    v_add_f32 v197, v197, v191
    v_cvt_pk_bf16_f32 v159, v190, v191
    v_mfma_f32_16x16x32_bf16 v[188:191], a[192:195], a[112:115], v[116:119]
    v_exp_f32 v184, v184
    v_mfma_f32_16x16x32_bf16 v[188:191], a[196:199], a[116:119], v[188:191]
    s_mov_b32 m0, s89
    v_exp_f32 v185, v185
    v_mfma_f32_16x16x32_bf16 v[188:191], a[200:203], a[120:123], v[188:191]
    ds_read_b64_tr_b16 a[236:237], v205 offset:32768
    v_add_f32 v192, v192, v184
    v_mfma_f32_16x16x32_bf16 v[188:191], a[204:207], a[124:127], v[188:191]
    buffer_load_dwordx4 v210, s[80:83], 0 offen nt lds
    v_exp_f32 v186, v186
    v_mfma_f32_16x16x32_bf16 a[16:19], a[224:227], v[152:155], a[16:19]
    ds_read_b64_tr_b16 a[238:239], v205 offset:36864
    v_cvt_pk_bf16_f32 v160, v184, v185
    v_mfma_f32_16x16x32_bf16 a[20:23], a[224:227], v[156:159], a[20:23]
    s_waitcnt lgkmcnt(4)
    v_exp_f32 v187, v187
    v_mfma_f32_16x16x32_bf16 a[24:27], a[228:231], v[136:139], a[24:27]
    v_add_f32 v192, v192, v185
    v_add_f32 v192, v192, v186
    v_mfma_f32_16x16x32_bf16 a[28:31], a[228:231], v[140:143], a[28:31]
    v_add_f32 v192, v192, v187
    v_cvt_pk_bf16_f32 v161, v186, v187
    v_mfma_f32_16x16x32_bf16 v[184:187], a[192:195], a[128:131], v[120:123]
    v_exp_f32 v188, v188
    v_mfma_f32_16x16x32_bf16 v[184:187], a[196:199], a[132:135], v[184:187]
    v_exp_f32 v189, v189
    v_mfma_f32_16x16x32_bf16 v[184:187], a[200:203], a[136:139], v[184:187]
    ds_read_b128 a[208:211], v198 offset:32768
    v_add_f32 v193, v193, v188
    v_mfma_f32_16x16x32_bf16 v[184:187], a[204:207], a[140:143], v[184:187]
    v_exp_f32 v190, v190
    v_mfma_f32_16x16x32_bf16 a[32:35], a[228:231], v[144:147], a[32:35]
    ds_read_b128 a[212:215], v199 offset:32768
    v_cvt_pk_bf16_f32 v164, v188, v189
    v_mfma_f32_16x16x32_bf16 a[36:39], a[228:231], v[148:151], a[36:39]
    v_exp_f32 v191, v191
    v_mfma_f32_16x16x32_bf16 a[40:43], a[228:231], v[152:155], a[40:43]
    v_add_f32 v193, v193, v189
    v_add_f32 v193, v193, v190
    v_mfma_f32_16x16x32_bf16 a[44:47], a[228:231], v[156:159], a[44:47]
    v_add_f32 v193, v193, v191
    v_cvt_pk_bf16_f32 v165, v190, v191
    v_mfma_f32_16x16x32_bf16 v[188:191], a[192:195], a[144:147], v[124:127]
    v_exp_f32 v184, v184
    v_mfma_f32_16x16x32_bf16 v[188:191], a[196:199], a[148:151], v[188:191]
    v_exp_f32 v185, v185
    v_mfma_f32_16x16x32_bf16 v[188:191], a[200:203], a[152:155], v[188:191]
    ds_read_b64_tr_b16 a[224:225], v206 offset:32768
    v_add_f32 v194, v194, v184
    v_mfma_f32_16x16x32_bf16 v[188:191], a[204:207], a[156:159], v[188:191]
    s_waitcnt lgkmcnt(5)
    v_exp_f32 v186, v186
    v_mfma_f32_16x16x32_bf16 a[48:51], a[232:235], v[136:139], a[48:51]
    ds_read_b64_tr_b16 a[226:227], v206 offset:36864
    v_cvt_pk_bf16_f32 v168, v184, v185
    v_mfma_f32_16x16x32_bf16 a[52:55], a[232:235], v[140:143], a[52:55]
    v_exp_f32 v187, v187
    v_mfma_f32_16x16x32_bf16 a[56:59], a[232:235], v[144:147], a[56:59]
    v_add_f32 v194, v194, v185
    v_add_f32 v194, v194, v186
    v_mfma_f32_16x16x32_bf16 a[60:63], a[232:235], v[148:151], a[60:63]
    v_add_f32 v194, v194, v187
    v_cvt_pk_bf16_f32 v169, v186, v187
    v_mfma_f32_16x16x32_bf16 v[184:187], a[192:195], a[160:163], v[128:131]
    v_exp_f32 v188, v188
    v_mfma_f32_16x16x32_bf16 v[184:187], a[196:199], a[164:167], v[184:187]
    v_exp_f32 v189, v189
    v_mfma_f32_16x16x32_bf16 v[184:187], a[200:203], a[168:171], v[184:187]
    ds_read_b128 a[216:219], v200 offset:32768
    v_add_f32 v195, v195, v188
    v_mfma_f32_16x16x32_bf16 v[184:187], a[204:207], a[172:175], v[184:187]
    buffer_load_dwordx4 v211, s[80:83], 0 offen offset:1024 nt lds
    v_exp_f32 v190, v190
    v_mfma_f32_16x16x32_bf16 a[64:67], a[232:235], v[152:155], a[64:67]
    ds_read_b128 a[220:223], v201 offset:32768
    v_cvt_pk_bf16_f32 v172, v188, v189
    v_mfma_f32_16x16x32_bf16 a[68:71], a[232:235], v[156:159], a[68:71]
    s_waitcnt lgkmcnt(6)
    v_exp_f32 v191, v191
    v_mfma_f32_16x16x32_bf16 a[72:75], a[236:239], v[136:139], a[72:75]
    v_add_f32 v195, v195, v189
    v_add_f32 v195, v195, v190
    v_mfma_f32_16x16x32_bf16 a[76:79], a[236:239], v[140:143], a[76:79]
    v_add_f32 v195, v195, v191
    v_cvt_pk_bf16_f32 v173, v190, v191
    v_mfma_f32_16x16x32_bf16 v[188:191], a[192:195], a[176:179], v[132:135]
    v_exp_f32 v184, v184
    v_mfma_f32_16x16x32_bf16 v[188:191], a[196:199], a[180:183], v[188:191]
    v_exp_f32 v185, v185
    v_mfma_f32_16x16x32_bf16 v[188:191], a[200:203], a[184:187], v[188:191]
    ds_read_b64_tr_b16 a[228:229], v207 offset:32768
    v_add_f32 v196, v196, v184
    v_mfma_f32_16x16x32_bf16 v[188:191], a[204:207], a[188:191], v[188:191]
    v_exp_f32 v186, v186
    v_mfma_f32_16x16x32_bf16 a[80:83], a[236:239], v[144:147], a[80:83]
    ds_read_b64_tr_b16 a[230:231], v207 offset:36864
    v_cvt_pk_bf16_f32 v176, v184, v185
    v_mfma_f32_16x16x32_bf16 a[84:87], a[236:239], v[148:151], a[84:87]
    v_exp_f32 v187, v187
    v_mfma_f32_16x16x32_bf16 a[88:91], a[236:239], v[152:155], a[88:91]
    v_add_f32 v196, v196, v185
    v_add_f32 v196, v196, v186
    v_mfma_f32_16x16x32_bf16 a[92:95], a[236:239], v[156:159], a[92:95]
    s_waitcnt lgkmcnt(2)
    v_add_f32 v196, v196, v187
    v_cvt_pk_bf16_f32 v177, v186, v187
    v_mfma_f32_16x16x32_bf16 v[184:187], a[208:211], a[96:99], v[112:115]
    v_exp_f32 v188, v188
    v_mfma_f32_16x16x32_bf16 v[184:187], a[212:215], a[100:103], v[184:187]
    v_exp_f32 v189, v189
    v_mfma_f32_16x16x32_bf16 v[184:187], a[216:219], a[104:107], v[184:187]
    ds_read_b64_tr_b16 a[232:233], v208 offset:32768
    v_add_f32 v197, v197, v188
    v_mfma_f32_16x16x32_bf16 v[184:187], a[220:223], a[108:111], v[184:187]
    v_exp_f32 v190, v190
    v_mfma_f32_16x16x32_bf16 v[16:19], a[224:227], v[136:139], v[16:19]
    ds_read_b64_tr_b16 a[234:235], v208 offset:36864
    v_cvt_pk_bf16_f32 v180, v188, v189
    v_mfma_f32_16x16x32_bf16 v[20:23], a[224:227], v[140:143], v[20:23]
    v_exp_f32 v191, v191
    v_mfma_f32_16x16x32_bf16 v[24:27], a[224:227], v[144:147], v[24:27]
    v_add_f32 v197, v197, v189
    v_add_f32 v197, v197, v190
    v_mfma_f32_16x16x32_bf16 v[28:31], a[224:227], v[148:151], v[28:31]
    v_add_f32 v197, v197, v191
    v_cvt_pk_bf16_f32 v181, v190, v191
    v_mfma_f32_16x16x32_bf16 v[188:191], a[208:211], a[112:115], v[116:119]
    v_exp_f32 v184, v184
    v_mfma_f32_16x16x32_bf16 v[188:191], a[212:215], a[116:119], v[188:191]
    v_exp_f32 v185, v185
    v_mfma_f32_16x16x32_bf16 v[188:191], a[216:219], a[120:123], v[188:191]
    ds_read_b64_tr_b16 a[236:237], v209 offset:32768
    v_add_f32 v192, v192, v184
    v_mfma_f32_16x16x32_bf16 v[188:191], a[220:223], a[124:127], v[188:191]
    buffer_load_dwordx4 v212, s[80:83], 0 offen offset:2048 nt lds
    v_exp_f32 v186, v186
    v_mfma_f32_16x16x32_bf16 v[32:35], a[224:227], v[152:155], v[32:35]
    ds_read_b64_tr_b16 a[238:239], v209 offset:36864
    v_cvt_pk_bf16_f32 v162, v184, v185
    v_mfma_f32_16x16x32_bf16 v[36:39], a[224:227], v[156:159], v[36:39]
    s_waitcnt lgkmcnt(4)
    v_exp_f32 v187, v187
    v_mfma_f32_16x16x32_bf16 v[40:43], a[228:231], v[136:139], v[40:43]
    v_add_f32 v192, v192, v185
    v_add_f32 v192, v192, v186
    v_mfma_f32_16x16x32_bf16 v[44:47], a[228:231], v[140:143], v[44:47]
    v_add_f32 v192, v192, v187
    v_cvt_pk_bf16_f32 v163, v186, v187
    v_mfma_f32_16x16x32_bf16 v[184:187], a[208:211], a[128:131], v[120:123]
    v_exp_f32 v188, v188
    v_mfma_f32_16x16x32_bf16 v[184:187], a[212:215], a[132:135], v[184:187]
    v_exp_f32 v189, v189
    v_mfma_f32_16x16x32_bf16 v[184:187], a[216:219], a[136:139], v[184:187]
    ds_read_b128 a[192:195], v198 offset:36864
    v_add_f32 v193, v193, v188
    v_mfma_f32_16x16x32_bf16 v[184:187], a[220:223], a[140:143], v[184:187]
    v_exp_f32 v190, v190
    v_mfma_f32_16x16x32_bf16 v[48:51], a[228:231], v[144:147], v[48:51]
    ds_read_b128 a[196:199], v199 offset:36864
    v_cvt_pk_bf16_f32 v166, v188, v189
    v_mfma_f32_16x16x32_bf16 v[52:55], a[228:231], v[148:151], v[52:55]
    v_exp_f32 v191, v191
    v_mfma_f32_16x16x32_bf16 v[56:59], a[228:231], v[152:155], v[56:59]
    v_add_f32 v193, v193, v189
    v_add_f32 v193, v193, v190
    v_mfma_f32_16x16x32_bf16 v[60:63], a[228:231], v[156:159], v[60:63]
    v_add_f32 v193, v193, v191
    v_cvt_pk_bf16_f32 v167, v190, v191
    v_mfma_f32_16x16x32_bf16 v[188:191], a[208:211], a[144:147], v[124:127]
    v_exp_f32 v184, v184
    v_mfma_f32_16x16x32_bf16 v[188:191], a[212:215], a[148:151], v[188:191]
    v_exp_f32 v185, v185
    v_mfma_f32_16x16x32_bf16 v[188:191], a[216:219], a[152:155], v[188:191]
    ds_read_b128 a[200:203], v200 offset:36864
    v_add_f32 v194, v194, v184
    v_mfma_f32_16x16x32_bf16 v[188:191], a[220:223], a[156:159], v[188:191]
    s_waitcnt lgkmcnt(5)
    v_exp_f32 v186, v186
    v_mfma_f32_16x16x32_bf16 v[64:67], a[232:235], v[136:139], v[64:67]
    ds_read_b128 a[204:207], v201 offset:36864
    v_cvt_pk_bf16_f32 v170, v184, v185
    v_mfma_f32_16x16x32_bf16 v[68:71], a[232:235], v[140:143], v[68:71]
    v_exp_f32 v187, v187
    v_mfma_f32_16x16x32_bf16 v[72:75], a[232:235], v[144:147], v[72:75]
    v_add_f32 v194, v194, v185
    v_add_f32 v194, v194, v186
    v_mfma_f32_16x16x32_bf16 v[76:79], a[232:235], v[148:151], v[76:79]
    v_add_f32 v194, v194, v187
    v_cvt_pk_bf16_f32 v171, v186, v187
    v_mfma_f32_16x16x32_bf16 v[184:187], a[208:211], a[160:163], v[128:131]
    v_exp_f32 v188, v188
    v_mfma_f32_16x16x32_bf16 v[184:187], a[212:215], a[164:167], v[184:187]
    v_exp_f32 v189, v189
    v_mfma_f32_16x16x32_bf16 v[184:187], a[216:219], a[168:171], v[184:187]
    ds_read_b64_tr_b16 a[224:225], v202 offset:40960
    v_add_f32 v195, v195, v188
    v_mfma_f32_16x16x32_bf16 v[184:187], a[220:223], a[172:175], v[184:187]
    buffer_load_dwordx4 v213, s[80:83], 0 offen offset:3072 nt lds
    v_exp_f32 v190, v190
    v_mfma_f32_16x16x32_bf16 v[80:83], a[232:235], v[152:155], v[80:83]
    ds_read_b64_tr_b16 a[226:227], v202 offset:45056
    v_cvt_pk_bf16_f32 v174, v188, v189
    v_mfma_f32_16x16x32_bf16 v[84:87], a[232:235], v[156:159], v[84:87]
    s_waitcnt lgkmcnt(6)
    v_exp_f32 v191, v191
    v_mfma_f32_16x16x32_bf16 v[88:91], a[236:239], v[136:139], v[88:91]
    s_add_u32 s80, s80, 16384
    v_add_f32 v195, v195, v189
    v_add_f32 v195, v195, v190
    v_mfma_f32_16x16x32_bf16 v[92:95], a[236:239], v[140:143], v[92:95]
    s_addc_u32 s81, s81, 0
    v_add_f32 v195, v195, v191
    v_cvt_pk_bf16_f32 v175, v190, v191
    v_mfma_f32_16x16x32_bf16 v[188:191], a[208:211], a[176:179], v[132:135]
    s_sub_i32 s82, s82, 16384
    v_exp_f32 v184, v184
    v_mfma_f32_16x16x32_bf16 v[188:191], a[212:215], a[180:183], v[188:191]
    s_max_i32 s82, s82, 0
    v_exp_f32 v185, v185
    v_mfma_f32_16x16x32_bf16 v[188:191], a[216:219], a[184:187], v[188:191]
    ds_read_b64_tr_b16 a[228:229], v203 offset:40960
    v_add_f32 v196, v196, v184
    v_mfma_f32_16x16x32_bf16 v[188:191], a[220:223], a[188:191], v[188:191]
    v_exp_f32 v186, v186
    v_mfma_f32_16x16x32_bf16 v[96:99], a[236:239], v[144:147], v[96:99]
    ds_read_b64_tr_b16 a[230:231], v203 offset:45056
    v_cvt_pk_bf16_f32 v178, v184, v185
    v_mfma_f32_16x16x32_bf16 v[100:103], a[236:239], v[148:151], v[100:103]
    v_exp_f32 v187, v187
    v_mfma_f32_16x16x32_bf16 v[104:107], a[236:239], v[152:155], v[104:107]
    v_add_f32 v196, v196, v185
    v_add_f32 v196, v196, v186
    v_mfma_f32_16x16x32_bf16 v[108:111], a[236:239], v[156:159], v[108:111]
    s_waitcnt lgkmcnt(4)
    v_add_f32 v196, v196, v187
    v_cvt_pk_bf16_f32 v179, v186, v187
    v_mfma_f32_16x16x32_bf16 v[184:187], a[192:195], a[96:99], v[112:115]
    v_exp_f32 v188, v188
    v_mfma_f32_16x16x32_bf16 v[184:187], a[196:199], a[100:103], v[184:187]
    v_exp_f32 v189, v189
    v_mfma_f32_16x16x32_bf16 v[184:187], a[200:203], a[104:107], v[184:187]
    ds_read_b64_tr_b16 a[232:233], v204 offset:40960
    v_add_f32 v197, v197, v188
    v_mfma_f32_16x16x32_bf16 v[184:187], a[204:207], a[108:111], v[184:187]
    s_waitcnt lgkmcnt(3)
    v_exp_f32 v190, v190
    v_mfma_f32_16x16x32_bf16 a[0:3], a[224:227], v[160:163], a[0:3]
    ds_read_b64_tr_b16 a[234:235], v204 offset:45056
    v_cvt_pk_bf16_f32 v182, v188, v189
    v_mfma_f32_16x16x32_bf16 a[4:7], a[224:227], v[164:167], a[4:7]
    v_exp_f32 v191, v191
    v_mfma_f32_16x16x32_bf16 a[8:11], a[224:227], v[168:171], a[8:11]
    v_add_f32 v197, v197, v189
    v_add_f32 v197, v197, v190
    v_mfma_f32_16x16x32_bf16 a[12:15], a[224:227], v[172:175], a[12:15]
    v_add_f32 v197, v197, v191
    v_cvt_pk_bf16_f32 v183, v190, v191
    v_mfma_f32_16x16x32_bf16 v[188:191], a[192:195], a[112:115], v[116:119]
    v_exp_f32 v184, v184
    v_mfma_f32_16x16x32_bf16 v[188:191], a[196:199], a[116:119], v[188:191]
    s_mov_b32 m0, s93
    v_exp_f32 v185, v185
    v_mfma_f32_16x16x32_bf16 v[188:191], a[200:203], a[120:123], v[188:191]
    ds_read_b64_tr_b16 a[236:237], v205 offset:40960
    v_add_f32 v192, v192, v184
    v_mfma_f32_16x16x32_bf16 v[188:191], a[204:207], a[124:127], v[188:191]
    buffer_load_dwordx4 v214, s[84:87], 0 offen nt lds
    v_exp_f32 v186, v186
    v_mfma_f32_16x16x32_bf16 a[16:19], a[224:227], v[176:179], a[16:19]
    ds_read_b64_tr_b16 a[238:239], v205 offset:45056
    v_cvt_pk_bf16_f32 v136, v184, v185
    v_mfma_f32_16x16x32_bf16 a[20:23], a[224:227], v[180:183], a[20:23]
    s_waitcnt lgkmcnt(4)
    v_exp_f32 v187, v187
    v_mfma_f32_16x16x32_bf16 a[24:27], a[228:231], v[160:163], a[24:27]
    v_add_f32 v192, v192, v185
    v_add_f32 v192, v192, v186
    v_mfma_f32_16x16x32_bf16 a[28:31], a[228:231], v[164:167], a[28:31]
    v_add_f32 v192, v192, v187
    v_cvt_pk_bf16_f32 v137, v186, v187
    v_mfma_f32_16x16x32_bf16 v[184:187], a[192:195], a[128:131], v[120:123]
    v_exp_f32 v188, v188
    v_mfma_f32_16x16x32_bf16 v[184:187], a[196:199], a[132:135], v[184:187]
    v_exp_f32 v189, v189
    v_mfma_f32_16x16x32_bf16 v[184:187], a[200:203], a[136:139], v[184:187]
    ds_read_b128 a[208:211], v198 offset:40960
    v_add_f32 v193, v193, v188
    v_mfma_f32_16x16x32_bf16 v[184:187], a[204:207], a[140:143], v[184:187]
    v_exp_f32 v190, v190
    v_mfma_f32_16x16x32_bf16 a[32:35], a[228:231], v[168:171], a[32:35]
    ds_read_b128 a[212:215], v199 offset:40960
    v_cvt_pk_bf16_f32 v140, v188, v189
    v_mfma_f32_16x16x32_bf16 a[36:39], a[228:231], v[172:175], a[36:39]
    v_exp_f32 v191, v191
    v_mfma_f32_16x16x32_bf16 a[40:43], a[228:231], v[176:179], a[40:43]
    v_add_f32 v193, v193, v189
    v_add_f32 v193, v193, v190
    v_mfma_f32_16x16x32_bf16 a[44:47], a[228:231], v[180:183], a[44:47]
    v_add_f32 v193, v193, v191
    v_cvt_pk_bf16_f32 v141, v190, v191
    v_mfma_f32_16x16x32_bf16 v[188:191], a[192:195], a[144:147], v[124:127]
    v_exp_f32 v184, v184
    v_mfma_f32_16x16x32_bf16 v[188:191], a[196:199], a[148:151], v[188:191]
    v_exp_f32 v185, v185
    v_mfma_f32_16x16x32_bf16 v[188:191], a[200:203], a[152:155], v[188:191]
    ds_read_b64_tr_b16 a[224:225], v206 offset:40960
    v_add_f32 v194, v194, v184
    v_mfma_f32_16x16x32_bf16 v[188:191], a[204:207], a[156:159], v[188:191]
    s_waitcnt lgkmcnt(5)
    v_exp_f32 v186, v186
    v_mfma_f32_16x16x32_bf16 a[48:51], a[232:235], v[160:163], a[48:51]
    ds_read_b64_tr_b16 a[226:227], v206 offset:45056
    v_cvt_pk_bf16_f32 v144, v184, v185
    v_mfma_f32_16x16x32_bf16 a[52:55], a[232:235], v[164:167], a[52:55]
    v_exp_f32 v187, v187
    v_mfma_f32_16x16x32_bf16 a[56:59], a[232:235], v[168:171], a[56:59]
    v_add_f32 v194, v194, v185
    v_add_f32 v194, v194, v186
    v_mfma_f32_16x16x32_bf16 a[60:63], a[232:235], v[172:175], a[60:63]
    v_add_f32 v194, v194, v187
    v_cvt_pk_bf16_f32 v145, v186, v187
    v_mfma_f32_16x16x32_bf16 v[184:187], a[192:195], a[160:163], v[128:131]
    v_exp_f32 v188, v188
    v_mfma_f32_16x16x32_bf16 v[184:187], a[196:199], a[164:167], v[184:187]
    v_exp_f32 v189, v189
    v_mfma_f32_16x16x32_bf16 v[184:187], a[200:203], a[168:171], v[184:187]
    ds_read_b128 a[216:219], v200 offset:40960
    v_add_f32 v195, v195, v188
    v_mfma_f32_16x16x32_bf16 v[184:187], a[204:207], a[172:175], v[184:187]
    buffer_load_dwordx4 v215, s[84:87], 0 offen offset:1024 nt lds
    v_exp_f32 v190, v190
    v_mfma_f32_16x16x32_bf16 a[64:67], a[232:235], v[176:179], a[64:67]
    ds_read_b128 a[220:223], v201 offset:40960
    v_cvt_pk_bf16_f32 v148, v188, v189
    v_mfma_f32_16x16x32_bf16 a[68:71], a[232:235], v[180:183], a[68:71]
    s_waitcnt lgkmcnt(6)
    v_exp_f32 v191, v191
    v_mfma_f32_16x16x32_bf16 a[72:75], a[236:239], v[160:163], a[72:75]
    v_add_f32 v195, v195, v189
    v_add_f32 v195, v195, v190
    v_mfma_f32_16x16x32_bf16 a[76:79], a[236:239], v[164:167], a[76:79]
    v_add_f32 v195, v195, v191
    v_cvt_pk_bf16_f32 v149, v190, v191
    v_mfma_f32_16x16x32_bf16 v[188:191], a[192:195], a[176:179], v[132:135]
    v_exp_f32 v184, v184
    v_mfma_f32_16x16x32_bf16 v[188:191], a[196:199], a[180:183], v[188:191]
    v_exp_f32 v185, v185
    v_mfma_f32_16x16x32_bf16 v[188:191], a[200:203], a[184:187], v[188:191]
    ds_read_b64_tr_b16 a[228:229], v207 offset:40960
    v_add_f32 v196, v196, v184
    v_mfma_f32_16x16x32_bf16 v[188:191], a[204:207], a[188:191], v[188:191]
    v_exp_f32 v186, v186
    v_mfma_f32_16x16x32_bf16 a[80:83], a[236:239], v[168:171], a[80:83]
    ds_read_b64_tr_b16 a[230:231], v207 offset:45056
    v_cvt_pk_bf16_f32 v152, v184, v185
    v_mfma_f32_16x16x32_bf16 a[84:87], a[236:239], v[172:175], a[84:87]
    v_exp_f32 v187, v187
    v_mfma_f32_16x16x32_bf16 a[88:91], a[236:239], v[176:179], a[88:91]
    v_add_f32 v196, v196, v185
    v_add_f32 v196, v196, v186
    v_mfma_f32_16x16x32_bf16 a[92:95], a[236:239], v[180:183], a[92:95]
    s_waitcnt lgkmcnt(2)
    v_add_f32 v196, v196, v187
    v_cvt_pk_bf16_f32 v153, v186, v187
    v_mfma_f32_16x16x32_bf16 v[184:187], a[208:211], a[96:99], v[112:115]
    v_exp_f32 v188, v188
    v_mfma_f32_16x16x32_bf16 v[184:187], a[212:215], a[100:103], v[184:187]
    v_exp_f32 v189, v189
    v_mfma_f32_16x16x32_bf16 v[184:187], a[216:219], a[104:107], v[184:187]
    ds_read_b64_tr_b16 a[232:233], v208 offset:40960
    v_add_f32 v197, v197, v188
    v_mfma_f32_16x16x32_bf16 v[184:187], a[220:223], a[108:111], v[184:187]
    v_exp_f32 v190, v190
    v_mfma_f32_16x16x32_bf16 v[16:19], a[224:227], v[160:163], v[16:19]
    ds_read_b64_tr_b16 a[234:235], v208 offset:45056
    v_cvt_pk_bf16_f32 v156, v188, v189
    v_mfma_f32_16x16x32_bf16 v[20:23], a[224:227], v[164:167], v[20:23]
    v_exp_f32 v191, v191
    v_mfma_f32_16x16x32_bf16 v[24:27], a[224:227], v[168:171], v[24:27]
    v_add_f32 v197, v197, v189
    v_add_f32 v197, v197, v190
    v_mfma_f32_16x16x32_bf16 v[28:31], a[224:227], v[172:175], v[28:31]
    v_add_f32 v197, v197, v191
    v_cvt_pk_bf16_f32 v157, v190, v191
    v_mfma_f32_16x16x32_bf16 v[188:191], a[208:211], a[112:115], v[116:119]
    v_exp_f32 v184, v184
    v_mfma_f32_16x16x32_bf16 v[188:191], a[212:215], a[116:119], v[188:191]
    v_exp_f32 v185, v185
    v_mfma_f32_16x16x32_bf16 v[188:191], a[216:219], a[120:123], v[188:191]
    ds_read_b64_tr_b16 a[236:237], v209 offset:40960
    v_add_f32 v192, v192, v184
    v_mfma_f32_16x16x32_bf16 v[188:191], a[220:223], a[124:127], v[188:191]
    buffer_load_dwordx4 v214, s[84:87], 0 offen offset:2048 nt lds
    v_exp_f32 v186, v186
    v_mfma_f32_16x16x32_bf16 v[32:35], a[224:227], v[176:179], v[32:35]
    ds_read_b64_tr_b16 a[238:239], v209 offset:45056
    v_cvt_pk_bf16_f32 v138, v184, v185
    v_mfma_f32_16x16x32_bf16 v[36:39], a[224:227], v[180:183], v[36:39]
    s_waitcnt lgkmcnt(4)
    v_exp_f32 v187, v187
    v_mfma_f32_16x16x32_bf16 v[40:43], a[228:231], v[160:163], v[40:43]
    v_add_f32 v192, v192, v185
    v_add_f32 v192, v192, v186
    v_mfma_f32_16x16x32_bf16 v[44:47], a[228:231], v[164:167], v[44:47]
    v_add_f32 v192, v192, v187
    v_cvt_pk_bf16_f32 v139, v186, v187
    v_mfma_f32_16x16x32_bf16 v[184:187], a[208:211], a[128:131], v[120:123]
    v_exp_f32 v188, v188
    v_mfma_f32_16x16x32_bf16 v[184:187], a[212:215], a[132:135], v[184:187]
    v_exp_f32 v189, v189
    v_mfma_f32_16x16x32_bf16 v[184:187], a[216:219], a[136:139], v[184:187]
    ds_read_b128 a[192:195], v198 offset:45056
    v_add_f32 v193, v193, v188
    v_mfma_f32_16x16x32_bf16 v[184:187], a[220:223], a[140:143], v[184:187]
    buffer_load_dwordx4 v215, s[84:87], 0 offen offset:3072 nt lds
    v_exp_f32 v190, v190
    v_mfma_f32_16x16x32_bf16 v[48:51], a[228:231], v[168:171], v[48:51]
    ds_read_b128 a[196:199], v199 offset:45056
    v_cvt_pk_bf16_f32 v142, v188, v189
    v_mfma_f32_16x16x32_bf16 v[52:55], a[228:231], v[172:175], v[52:55]
    s_add_u32 s84, s84, 16384
    v_exp_f32 v191, v191
    v_mfma_f32_16x16x32_bf16 v[56:59], a[228:231], v[176:179], v[56:59]
    s_addc_u32 s85, s85, 0
    v_add_f32 v193, v193, v189
    v_add_f32 v193, v193, v190
    v_mfma_f32_16x16x32_bf16 v[60:63], a[228:231], v[180:183], v[60:63]
    s_sub_i32 s86, s86, 16384
    v_add_f32 v193, v193, v191
    v_cvt_pk_bf16_f32 v143, v190, v191
    v_mfma_f32_16x16x32_bf16 v[188:191], a[208:211], a[144:147], v[124:127]
    s_max_i32 s86, s86, 0
    v_exp_f32 v184, v184
    v_mfma_f32_16x16x32_bf16 v[188:191], a[212:215], a[148:151], v[188:191]
    v_exp_f32 v185, v185
    v_mfma_f32_16x16x32_bf16 v[188:191], a[216:219], a[152:155], v[188:191]
    ds_read_b128 a[200:203], v200 offset:45056
    v_add_f32 v194, v194, v184
    v_mfma_f32_16x16x32_bf16 v[188:191], a[220:223], a[156:159], v[188:191]
    s_waitcnt lgkmcnt(5)
    v_exp_f32 v186, v186
    v_mfma_f32_16x16x32_bf16 v[64:67], a[232:235], v[160:163], v[64:67]
    ds_read_b128 a[204:207], v201 offset:45056
    v_cvt_pk_bf16_f32 v146, v184, v185
    v_mfma_f32_16x16x32_bf16 v[68:71], a[232:235], v[164:167], v[68:71]
    v_exp_f32 v187, v187
    v_mfma_f32_16x16x32_bf16 v[72:75], a[232:235], v[168:171], v[72:75]
    v_add_f32 v194, v194, v185
    v_add_f32 v194, v194, v186
    v_mfma_f32_16x16x32_bf16 v[76:79], a[232:235], v[172:175], v[76:79]
    v_add_f32 v194, v194, v187
    v_cvt_pk_bf16_f32 v147, v186, v187
    v_mfma_f32_16x16x32_bf16 v[184:187], a[208:211], a[160:163], v[128:131]
    s_waitcnt vmcnt(16) lgkmcnt(0)
    v_exp_f32 v188, v188
    v_mfma_f32_16x16x32_bf16 v[184:187], a[212:215], a[164:167], v[184:187]
    s_barrier
    v_exp_f32 v189, v189
    v_mfma_f32_16x16x32_bf16 v[184:187], a[216:219], a[168:171], v[184:187]
    ds_read_b64_tr_b16 a[224:225], v202 offset:49152
    v_add_f32 v195, v195, v188
    v_mfma_f32_16x16x32_bf16 v[184:187], a[220:223], a[172:175], v[184:187]
    v_exp_f32 v190, v190
    v_mfma_f32_16x16x32_bf16 v[80:83], a[232:235], v[176:179], v[80:83]
    ds_read_b64_tr_b16 a[226:227], v202 offset:53248
    v_cvt_pk_bf16_f32 v150, v188, v189
    v_mfma_f32_16x16x32_bf16 v[84:87], a[232:235], v[180:183], v[84:87]
    v_exp_f32 v191, v191
    v_mfma_f32_16x16x32_bf16 v[88:91], a[236:239], v[160:163], v[88:91]
    v_add_f32 v195, v195, v189
    v_add_f32 v195, v195, v190
    v_mfma_f32_16x16x32_bf16 v[92:95], a[236:239], v[164:167], v[92:95]
    v_add_f32 v195, v195, v191
    v_cvt_pk_bf16_f32 v151, v190, v191
    v_mfma_f32_16x16x32_bf16 v[188:191], a[208:211], a[176:179], v[132:135]
    v_exp_f32 v184, v184
    v_mfma_f32_16x16x32_bf16 v[188:191], a[212:215], a[180:183], v[188:191]
    v_exp_f32 v185, v185
    v_mfma_f32_16x16x32_bf16 v[188:191], a[216:219], a[184:187], v[188:191]
    ds_read_b64_tr_b16 a[228:229], v203 offset:49152
    v_add_f32 v196, v196, v184
    v_mfma_f32_16x16x32_bf16 v[188:191], a[220:223], a[188:191], v[188:191]
    v_exp_f32 v186, v186
    v_mfma_f32_16x16x32_bf16 v[96:99], a[236:239], v[168:171], v[96:99]
    ds_read_b64_tr_b16 a[230:231], v203 offset:53248
    v_cvt_pk_bf16_f32 v154, v184, v185
    v_mfma_f32_16x16x32_bf16 v[100:103], a[236:239], v[172:175], v[100:103]
    v_exp_f32 v187, v187
    v_mfma_f32_16x16x32_bf16 v[104:107], a[236:239], v[176:179], v[104:107]
    s_cmp_eq_u32 s36, 7
    v_add_f32 v196, v196, v185
    v_add_f32 v196, v196, v186
    v_mfma_f32_16x16x32_bf16 v[108:111], a[236:239], v[180:183], v[108:111]
    v_add_f32 v196, v196, v187
    v_cvt_pk_bf16_f32 v155, v186, v187
    s_cbranch_scc1 L_tail
    v_mfma_f32_16x16x32_bf16 v[184:187], a[192:195], a[96:99], v[112:115]
    v_exp_f32 v188, v188
    v_mfma_f32_16x16x32_bf16 v[184:187], a[196:199], a[100:103], v[184:187]
    v_exp_f32 v189, v189
    v_mfma_f32_16x16x32_bf16 v[184:187], a[200:203], a[104:107], v[184:187]
    ds_read_b64_tr_b16 a[232:233], v204 offset:49152
    v_add_f32 v197, v197, v188
    v_mfma_f32_16x16x32_bf16 v[184:187], a[204:207], a[108:111], v[184:187]
    s_waitcnt lgkmcnt(3)
    v_exp_f32 v190, v190
    v_mfma_f32_16x16x32_bf16 a[0:3], a[224:227], v[136:139], a[0:3]
    ds_read_b64_tr_b16 a[234:235], v204 offset:53248
    v_cvt_pk_bf16_f32 v158, v188, v189
    v_mfma_f32_16x16x32_bf16 a[4:7], a[224:227], v[140:143], a[4:7]
    v_exp_f32 v191, v191
    v_mfma_f32_16x16x32_bf16 a[8:11], a[224:227], v[144:147], a[8:11]
    v_add_f32 v197, v197, v189
    v_add_f32 v197, v197, v190
    v_mfma_f32_16x16x32_bf16 a[12:15], a[224:227], v[148:151], a[12:15]
    v_add_f32 v197, v197, v191
    v_cvt_pk_bf16_f32 v159, v190, v191
    v_mfma_f32_16x16x32_bf16 v[188:191], a[192:195], a[112:115], v[116:119]
    v_exp_f32 v184, v184
    v_mfma_f32_16x16x32_bf16 v[188:191], a[196:199], a[116:119], v[188:191]
    s_mov_b32 m0, s90
    v_exp_f32 v185, v185
    v_mfma_f32_16x16x32_bf16 v[188:191], a[200:203], a[120:123], v[188:191]
    ds_read_b64_tr_b16 a[236:237], v205 offset:49152
    v_add_f32 v192, v192, v184
    v_mfma_f32_16x16x32_bf16 v[188:191], a[204:207], a[124:127], v[188:191]
    buffer_load_dwordx4 v210, s[80:83], 0 offen nt lds
    v_exp_f32 v186, v186
    v_mfma_f32_16x16x32_bf16 a[16:19], a[224:227], v[152:155], a[16:19]
    ds_read_b64_tr_b16 a[238:239], v205 offset:53248
    v_cvt_pk_bf16_f32 v160, v184, v185
    v_mfma_f32_16x16x32_bf16 a[20:23], a[224:227], v[156:159], a[20:23]
    s_waitcnt lgkmcnt(4)
    v_exp_f32 v187, v187
    v_mfma_f32_16x16x32_bf16 a[24:27], a[228:231], v[136:139], a[24:27]
    v_add_f32 v192, v192, v185
    v_add_f32 v192, v192, v186
    v_mfma_f32_16x16x32_bf16 a[28:31], a[228:231], v[140:143], a[28:31]
    v_add_f32 v192, v192, v187
    v_cvt_pk_bf16_f32 v161, v186, v187
    v_mfma_f32_16x16x32_bf16 v[184:187], a[192:195], a[128:131], v[120:123]
    v_exp_f32 v188, v188
    v_mfma_f32_16x16x32_bf16 v[184:187], a[196:199], a[132:135], v[184:187]
    v_exp_f32 v189, v189
    v_mfma_f32_16x16x32_bf16 v[184:187], a[200:203], a[136:139], v[184:187]
    ds_read_b128 a[208:211], v198 offset:49152
    v_add_f32 v193, v193, v188
    v_mfma_f32_16x16x32_bf16 v[184:187], a[204:207], a[140:143], v[184:187]
    v_exp_f32 v190, v190
    v_mfma_f32_16x16x32_bf16 a[32:35], a[228:231], v[144:147], a[32:35]
    ds_read_b128 a[212:215], v199 offset:49152
    v_cvt_pk_bf16_f32 v164, v188, v189
    v_mfma_f32_16x16x32_bf16 a[36:39], a[228:231], v[148:151], a[36:39]
    v_exp_f32 v191, v191
    v_mfma_f32_16x16x32_bf16 a[40:43], a[228:231], v[152:155], a[40:43]
    v_add_f32 v193, v193, v189
    v_add_f32 v193, v193, v190
    v_mfma_f32_16x16x32_bf16 a[44:47], a[228:231], v[156:159], a[44:47]
    v_add_f32 v193, v193, v191
    v_cvt_pk_bf16_f32 v165, v190, v191
    v_mfma_f32_16x16x32_bf16 v[188:191], a[192:195], a[144:147], v[124:127]
    v_exp_f32 v184, v184
    v_mfma_f32_16x16x32_bf16 v[188:191], a[196:199], a[148:151], v[188:191]
    v_exp_f32 v185, v185
    v_mfma_f32_16x16x32_bf16 v[188:191], a[200:203], a[152:155], v[188:191]
    ds_read_b64_tr_b16 a[224:225], v206 offset:49152
    v_add_f32 v194, v194, v184
    v_mfma_f32_16x16x32_bf16 v[188:191], a[204:207], a[156:159], v[188:191]
    s_waitcnt lgkmcnt(5)
    v_exp_f32 v186, v186
    v_mfma_f32_16x16x32_bf16 a[48:51], a[232:235], v[136:139], a[48:51]
    ds_read_b64_tr_b16 a[226:227], v206 offset:53248
    v_cvt_pk_bf16_f32 v168, v184, v185
    v_mfma_f32_16x16x32_bf16 a[52:55], a[232:235], v[140:143], a[52:55]
    v_exp_f32 v187, v187
    v_mfma_f32_16x16x32_bf16 a[56:59], a[232:235], v[144:147], a[56:59]
    v_add_f32 v194, v194, v185
    v_add_f32 v194, v194, v186
    v_mfma_f32_16x16x32_bf16 a[60:63], a[232:235], v[148:151], a[60:63]
    v_add_f32 v194, v194, v187
    v_cvt_pk_bf16_f32 v169, v186, v187
    v_mfma_f32_16x16x32_bf16 v[184:187], a[192:195], a[160:163], v[128:131]
    v_exp_f32 v188, v188
    v_mfma_f32_16x16x32_bf16 v[184:187], a[196:199], a[164:167], v[184:187]
    v_exp_f32 v189, v189
    v_mfma_f32_16x16x32_bf16 v[184:187], a[200:203], a[168:171], v[184:187]
    ds_read_b128 a[216:219], v200 offset:49152
    v_add_f32 v195, v195, v188
    v_mfma_f32_16x16x32_bf16 v[184:187], a[204:207], a[172:175], v[184:187]
    buffer_load_dwordx4 v211, s[80:83], 0 offen offset:1024 nt lds
    v_exp_f32 v190, v190
    v_mfma_f32_16x16x32_bf16 a[64:67], a[232:235], v[152:155], a[64:67]
    ds_read_b128 a[220:223], v201 offset:49152
    v_cvt_pk_bf16_f32 v172, v188, v189
    v_mfma_f32_16x16x32_bf16 a[68:71], a[232:235], v[156:159], a[68:71]
    s_waitcnt lgkmcnt(6)
    v_exp_f32 v191, v191
    v_mfma_f32_16x16x32_bf16 a[72:75], a[236:239], v[136:139], a[72:75]
    v_add_f32 v195, v195, v189
    v_add_f32 v195, v195, v190
    v_mfma_f32_16x16x32_bf16 a[76:79], a[236:239], v[140:143], a[76:79]
    v_add_f32 v195, v195, v191
    v_cvt_pk_bf16_f32 v173, v190, v191
    v_mfma_f32_16x16x32_bf16 v[188:191], a[192:195], a[176:179], v[132:135]
    v_exp_f32 v184, v184
    v_mfma_f32_16x16x32_bf16 v[188:191], a[196:199], a[180:183], v[188:191]
    v_exp_f32 v185, v185
    v_mfma_f32_16x16x32_bf16 v[188:191], a[200:203], a[184:187], v[188:191]
    ds_read_b64_tr_b16 a[228:229], v207 offset:49152
    v_add_f32 v196, v196, v184
    v_mfma_f32_16x16x32_bf16 v[188:191], a[204:207], a[188:191], v[188:191]
    v_exp_f32 v186, v186
    v_mfma_f32_16x16x32_bf16 a[80:83], a[236:239], v[144:147], a[80:83]
    ds_read_b64_tr_b16 a[230:231], v207 offset:53248
    v_cvt_pk_bf16_f32 v176, v184, v185
    v_mfma_f32_16x16x32_bf16 a[84:87], a[236:239], v[148:151], a[84:87]
    v_exp_f32 v187, v187
    v_mfma_f32_16x16x32_bf16 a[88:91], a[236:239], v[152:155], a[88:91]
    v_add_f32 v196, v196, v185
    v_add_f32 v196, v196, v186
    v_mfma_f32_16x16x32_bf16 a[92:95], a[236:239], v[156:159], a[92:95]
    s_waitcnt lgkmcnt(2)
    v_add_f32 v196, v196, v187
    v_cvt_pk_bf16_f32 v177, v186, v187
    v_mfma_f32_16x16x32_bf16 v[184:187], a[208:211], a[96:99], v[112:115]
    v_exp_f32 v188, v188
    v_mfma_f32_16x16x32_bf16 v[184:187], a[212:215], a[100:103], v[184:187]
    v_exp_f32 v189, v189
    v_mfma_f32_16x16x32_bf16 v[184:187], a[216:219], a[104:107], v[184:187]
    ds_read_b64_tr_b16 a[232:233], v208 offset:49152
    v_add_f32 v197, v197, v188
    v_mfma_f32_16x16x32_bf16 v[184:187], a[220:223], a[108:111], v[184:187]
    v_exp_f32 v190, v190
    v_mfma_f32_16x16x32_bf16 v[16:19], a[224:227], v[136:139], v[16:19]
    ds_read_b64_tr_b16 a[234:235], v208 offset:53248
    v_cvt_pk_bf16_f32 v180, v188, v189
    v_mfma_f32_16x16x32_bf16 v[20:23], a[224:227], v[140:143], v[20:23]
    v_exp_f32 v191, v191
    v_mfma_f32_16x16x32_bf16 v[24:27], a[224:227], v[144:147], v[24:27]
    v_add_f32 v197, v197, v189
    v_add_f32 v197, v197, v190
    v_mfma_f32_16x16x32_bf16 v[28:31], a[224:227], v[148:151], v[28:31]
    v_add_f32 v197, v197, v191
    v_cvt_pk_bf16_f32 v181, v190, v191
    v_mfma_f32_16x16x32_bf16 v[188:191], a[208:211], a[112:115], v[116:119]
    v_exp_f32 v184, v184
    v_mfma_f32_16x16x32_bf16 v[188:191], a[212:215], a[116:119], v[188:191]
    v_exp_f32 v185, v185
    v_mfma_f32_16x16x32_bf16 v[188:191], a[216:219], a[120:123], v[188:191]
    ds_read_b64_tr_b16 a[236:237], v209 offset:49152
    v_add_f32 v192, v192, v184
    v_mfma_f32_16x16x32_bf16 v[188:191], a[220:223], a[124:127], v[188:191]
    buffer_load_dwordx4 v212, s[80:83], 0 offen offset:2048 nt lds
    v_exp_f32 v186, v186
    v_mfma_f32_16x16x32_bf16 v[32:35], a[224:227], v[152:155], v[32:35]
    ds_read_b64_tr_b16 a[238:239], v209 offset:53248
    v_cvt_pk_bf16_f32 v162, v184, v185
    v_mfma_f32_16x16x32_bf16 v[36:39], a[224:227], v[156:159], v[36:39]
    s_waitcnt lgkmcnt(4)
    v_exp_f32 v187, v187
    v_mfma_f32_16x16x32_bf16 v[40:43], a[228:231], v[136:139], v[40:43]
    v_add_f32 v192, v192, v185
    v_add_f32 v192, v192, v186
    v_mfma_f32_16x16x32_bf16 v[44:47], a[228:231], v[140:143], v[44:47]
    v_add_f32 v192, v192, v187
    v_cvt_pk_bf16_f32 v163, v186, v187
    v_mfma_f32_16x16x32_bf16 v[184:187], a[208:211], a[128:131], v[120:123]
    v_exp_f32 v188, v188
    v_mfma_f32_16x16x32_bf16 v[184:187], a[212:215], a[132:135], v[184:187]
    v_exp_f32 v189, v189
    v_mfma_f32_16x16x32_bf16 v[184:187], a[216:219], a[136:139], v[184:187]
    ds_read_b128 a[192:195], v198 offset:53248
    v_add_f32 v193, v193, v188
    v_mfma_f32_16x16x32_bf16 v[184:187], a[220:223], a[140:143], v[184:187]
    v_exp_f32 v190, v190
    v_mfma_f32_16x16x32_bf16 v[48:51], a[228:231], v[144:147], v[48:51]
    ds_read_b128 a[196:199], v199 offset:53248
    v_cvt_pk_bf16_f32 v166, v188, v189
    v_mfma_f32_16x16x32_bf16 v[52:55], a[228:231], v[148:151], v[52:55]
    v_exp_f32 v191, v191
    v_mfma_f32_16x16x32_bf16 v[56:59], a[228:231], v[152:155], v[56:59]
    v_add_f32 v193, v193, v189
    v_add_f32 v193, v193, v190
    v_mfma_f32_16x16x32_bf16 v[60:63], a[228:231], v[156:159], v[60:63]
    v_add_f32 v193, v193, v191
    v_cvt_pk_bf16_f32 v167, v190, v191
    v_mfma_f32_16x16x32_bf16 v[188:191], a[208:211], a[144:147], v[124:127]
    v_exp_f32 v184, v184
    v_mfma_f32_16x16x32_bf16 v[188:191], a[212:215], a[148:151], v[188:191]
    v_exp_f32 v185, v185
    v_mfma_f32_16x16x32_bf16 v[188:191], a[216:219], a[152:155], v[188:191]
    ds_read_b128 a[200:203], v200 offset:53248
    v_add_f32 v194, v194, v184
    v_mfma_f32_16x16x32_bf16 v[188:191], a[220:223], a[156:159], v[188:191]
    s_waitcnt lgkmcnt(5)
    v_exp_f32 v186, v186
    v_mfma_f32_16x16x32_bf16 v[64:67], a[232:235], v[136:139], v[64:67]
    ds_read_b128 a[204:207], v201 offset:53248
    v_cvt_pk_bf16_f32 v170, v184, v185
    v_mfma_f32_16x16x32_bf16 v[68:71], a[232:235], v[140:143], v[68:71]
    v_exp_f32 v187, v187
    v_mfma_f32_16x16x32_bf16 v[72:75], a[232:235], v[144:147], v[72:75]
    v_add_f32 v194, v194, v185
    v_add_f32 v194, v194, v186
    v_mfma_f32_16x16x32_bf16 v[76:79], a[232:235], v[148:151], v[76:79]
    v_add_f32 v194, v194, v187
    v_cvt_pk_bf16_f32 v171, v186, v187
    v_mfma_f32_16x16x32_bf16 v[184:187], a[208:211], a[160:163], v[128:131]
    v_exp_f32 v188, v188
    v_mfma_f32_16x16x32_bf16 v[184:187], a[212:215], a[164:167], v[184:187]
    v_exp_f32 v189, v189
    v_mfma_f32_16x16x32_bf16 v[184:187], a[216:219], a[168:171], v[184:187]
    ds_read_b64_tr_b16 a[224:225], v202 offset:57344
    v_add_f32 v195, v195, v188
    v_mfma_f32_16x16x32_bf16 v[184:187], a[220:223], a[172:175], v[184:187]
    buffer_load_dwordx4 v213, s[80:83], 0 offen offset:3072 nt lds
    v_exp_f32 v190, v190
    v_mfma_f32_16x16x32_bf16 v[80:83], a[232:235], v[152:155], v[80:83]
    ds_read_b64_tr_b16 a[226:227], v202 offset:61440
    v_cvt_pk_bf16_f32 v174, v188, v189
    v_mfma_f32_16x16x32_bf16 v[84:87], a[232:235], v[156:159], v[84:87]
    s_waitcnt lgkmcnt(6)
    v_exp_f32 v191, v191
    v_mfma_f32_16x16x32_bf16 v[88:91], a[236:239], v[136:139], v[88:91]
    s_add_u32 s80, s80, 16384
    v_add_f32 v195, v195, v189
    v_add_f32 v195, v195, v190
    v_mfma_f32_16x16x32_bf16 v[92:95], a[236:239], v[140:143], v[92:95]
    s_addc_u32 s81, s81, 0
    v_add_f32 v195, v195, v191
    v_cvt_pk_bf16_f32 v175, v190, v191
    v_mfma_f32_16x16x32_bf16 v[188:191], a[208:211], a[176:179], v[132:135]
    s_sub_i32 s82, s82, 16384
    v_exp_f32 v184, v184
    v_mfma_f32_16x16x32_bf16 v[188:191], a[212:215], a[180:183], v[188:191]
    s_max_i32 s82, s82, 0
    v_exp_f32 v185, v185
    v_mfma_f32_16x16x32_bf16 v[188:191], a[216:219], a[184:187], v[188:191]
    ds_read_b64_tr_b16 a[228:229], v203 offset:57344
    v_add_f32 v196, v196, v184
    v_mfma_f32_16x16x32_bf16 v[188:191], a[220:223], a[188:191], v[188:191]
    v_exp_f32 v186, v186
    v_mfma_f32_16x16x32_bf16 v[96:99], a[236:239], v[144:147], v[96:99]
    ds_read_b64_tr_b16 a[230:231], v203 offset:61440
    v_cvt_pk_bf16_f32 v178, v184, v185
    v_mfma_f32_16x16x32_bf16 v[100:103], a[236:239], v[148:151], v[100:103]
    v_exp_f32 v187, v187
    v_mfma_f32_16x16x32_bf16 v[104:107], a[236:239], v[152:155], v[104:107]
    v_add_f32 v196, v196, v185
    v_add_f32 v196, v196, v186
    v_mfma_f32_16x16x32_bf16 v[108:111], a[236:239], v[156:159], v[108:111]
    s_waitcnt lgkmcnt(4)
    v_add_f32 v196, v196, v187
    v_cvt_pk_bf16_f32 v179, v186, v187
    v_mfma_f32_16x16x32_bf16 v[184:187], a[192:195], a[96:99], v[112:115]
    v_exp_f32 v188, v188
    v_mfma_f32_16x16x32_bf16 v[184:187], a[196:199], a[100:103], v[184:187]
    v_exp_f32 v189, v189
    v_mfma_f32_16x16x32_bf16 v[184:187], a[200:203], a[104:107], v[184:187]
    ds_read_b64_tr_b16 a[232:233], v204 offset:57344
    v_add_f32 v197, v197, v188
    v_mfma_f32_16x16x32_bf16 v[184:187], a[204:207], a[108:111], v[184:187]
    s_waitcnt lgkmcnt(3)
    v_exp_f32 v190, v190
    v_mfma_f32_16x16x32_bf16 a[0:3], a[224:227], v[160:163], a[0:3]
    ds_read_b64_tr_b16 a[234:235], v204 offset:61440
    v_cvt_pk_bf16_f32 v182, v188, v189
    v_mfma_f32_16x16x32_bf16 a[4:7], a[224:227], v[164:167], a[4:7]
    v_exp_f32 v191, v191
    v_mfma_f32_16x16x32_bf16 a[8:11], a[224:227], v[168:171], a[8:11]
    v_add_f32 v197, v197, v189
    v_add_f32 v197, v197, v190
    v_mfma_f32_16x16x32_bf16 a[12:15], a[224:227], v[172:175], a[12:15]
    v_add_f32 v197, v197, v191
    v_cvt_pk_bf16_f32 v183, v190, v191
    v_mfma_f32_16x16x32_bf16 v[188:191], a[192:195], a[112:115], v[116:119]
    v_exp_f32 v184, v184
    v_mfma_f32_16x16x32_bf16 v[188:191], a[196:199], a[116:119], v[188:191]
    s_mov_b32 m0, s94
    v_exp_f32 v185, v185
    v_mfma_f32_16x16x32_bf16 v[188:191], a[200:203], a[120:123], v[188:191]
    ds_read_b64_tr_b16 a[236:237], v205 offset:57344
    v_add_f32 v192, v192, v184
    v_mfma_f32_16x16x32_bf16 v[188:191], a[204:207], a[124:127], v[188:191]
    buffer_load_dwordx4 v214, s[84:87], 0 offen nt lds
    v_exp_f32 v186, v186
    v_mfma_f32_16x16x32_bf16 a[16:19], a[224:227], v[176:179], a[16:19]
    ds_read_b64_tr_b16 a[238:239], v205 offset:61440
    v_cvt_pk_bf16_f32 v136, v184, v185
    v_mfma_f32_16x16x32_bf16 a[20:23], a[224:227], v[180:183], a[20:23]
    s_waitcnt lgkmcnt(4)
    v_exp_f32 v187, v187
    v_mfma_f32_16x16x32_bf16 a[24:27], a[228:231], v[160:163], a[24:27]
    v_add_f32 v192, v192, v185
    v_add_f32 v192, v192, v186
    v_mfma_f32_16x16x32_bf16 a[28:31], a[228:231], v[164:167], a[28:31]
    v_add_f32 v192, v192, v187
    v_cvt_pk_bf16_f32 v137, v186, v187
    v_mfma_f32_16x16x32_bf16 v[184:187], a[192:195], a[128:131], v[120:123]
    v_exp_f32 v188, v188
    v_mfma_f32_16x16x32_bf16 v[184:187], a[196:199], a[132:135], v[184:187]
    v_exp_f32 v189, v189
    v_mfma_f32_16x16x32_bf16 v[184:187], a[200:203], a[136:139], v[184:187]
    ds_read_b128 a[208:211], v198 offset:57344
    v_add_f32 v193, v193, v188
    v_mfma_f32_16x16x32_bf16 v[184:187], a[204:207], a[140:143], v[184:187]
    v_exp_f32 v190, v190
    v_mfma_f32_16x16x32_bf16 a[32:35], a[228:231], v[168:171], a[32:35]
    ds_read_b128 a[212:215], v199 offset:57344
    v_cvt_pk_bf16_f32 v140, v188, v189
    v_mfma_f32_16x16x32_bf16 a[36:39], a[228:231], v[172:175], a[36:39]
    v_exp_f32 v191, v191
    v_mfma_f32_16x16x32_bf16 a[40:43], a[228:231], v[176:179], a[40:43]
    v_add_f32 v193, v193, v189
    v_add_f32 v193, v193, v190
    v_mfma_f32_16x16x32_bf16 a[44:47], a[228:231], v[180:183], a[44:47]
    v_add_f32 v193, v193, v191
    v_cvt_pk_bf16_f32 v141, v190, v191
    v_mfma_f32_16x16x32_bf16 v[188:191], a[192:195], a[144:147], v[124:127]
    v_exp_f32 v184, v184
    v_mfma_f32_16x16x32_bf16 v[188:191], a[196:199], a[148:151], v[188:191]
    v_exp_f32 v185, v185
    v_mfma_f32_16x16x32_bf16 v[188:191], a[200:203], a[152:155], v[188:191]
    ds_read_b64_tr_b16 a[224:225], v206 offset:57344
    v_add_f32 v194, v194, v184
    v_mfma_f32_16x16x32_bf16 v[188:191], a[204:207], a[156:159], v[188:191]
    s_waitcnt lgkmcnt(5)
    v_exp_f32 v186, v186
    v_mfma_f32_16x16x32_bf16 a[48:51], a[232:235], v[160:163], a[48:51]
    ds_read_b64_tr_b16 a[226:227], v206 offset:61440
    v_cvt_pk_bf16_f32 v144, v184, v185
    v_mfma_f32_16x16x32_bf16 a[52:55], a[232:235], v[164:167], a[52:55]
    v_exp_f32 v187, v187
    v_mfma_f32_16x16x32_bf16 a[56:59], a[232:235], v[168:171], a[56:59]
    v_add_f32 v194, v194, v185
    v_add_f32 v194, v194, v186
    v_mfma_f32_16x16x32_bf16 a[60:63], a[232:235], v[172:175], a[60:63]
    v_add_f32 v194, v194, v187
    v_cvt_pk_bf16_f32 v145, v186, v187
    v_mfma_f32_16x16x32_bf16 v[184:187], a[192:195], a[160:163], v[128:131]
    v_exp_f32 v188, v188
    v_mfma_f32_16x16x32_bf16 v[184:187], a[196:199], a[164:167], v[184:187]
    v_exp_f32 v189, v189
    v_mfma_f32_16x16x32_bf16 v[184:187], a[200:203], a[168:171], v[184:187]
    ds_read_b128 a[216:219], v200 offset:57344
    v_add_f32 v195, v195, v188
    v_mfma_f32_16x16x32_bf16 v[184:187], a[204:207], a[172:175], v[184:187]
    buffer_load_dwordx4 v215, s[84:87], 0 offen offset:1024 nt lds
    v_exp_f32 v190, v190
    v_mfma_f32_16x16x32_bf16 a[64:67], a[232:235], v[176:179], a[64:67]
    ds_read_b128 a[220:223], v201 offset:57344
    v_cvt_pk_bf16_f32 v148, v188, v189
    v_mfma_f32_16x16x32_bf16 a[68:71], a[232:235], v[180:183], a[68:71]
    s_waitcnt lgkmcnt(6)
    v_exp_f32 v191, v191
    v_mfma_f32_16x16x32_bf16 a[72:75], a[236:239], v[160:163], a[72:75]
    v_add_f32 v195, v195, v189
    v_add_f32 v195, v195, v190
    v_mfma_f32_16x16x32_bf16 a[76:79], a[236:239], v[164:167], a[76:79]
    v_add_f32 v195, v195, v191
    v_cvt_pk_bf16_f32 v149, v190, v191
    v_mfma_f32_16x16x32_bf16 v[188:191], a[192:195], a[176:179], v[132:135]
    v_exp_f32 v184, v184
    v_mfma_f32_16x16x32_bf16 v[188:191], a[196:199], a[180:183], v[188:191]
    v_exp_f32 v185, v185
    v_mfma_f32_16x16x32_bf16 v[188:191], a[200:203], a[184:187], v[188:191]
    ds_read_b64_tr_b16 a[228:229], v207 offset:57344
    v_add_f32 v196, v196, v184
    v_mfma_f32_16x16x32_bf16 v[188:191], a[204:207], a[188:191], v[188:191]
    v_exp_f32 v186, v186
    v_mfma_f32_16x16x32_bf16 a[80:83], a[236:239], v[168:171], a[80:83]
    ds_read_b64_tr_b16 a[230:231], v207 offset:61440
    v_cvt_pk_bf16_f32 v152, v184, v185
    v_mfma_f32_16x16x32_bf16 a[84:87], a[236:239], v[172:175], a[84:87]
    v_exp_f32 v187, v187
    v_mfma_f32_16x16x32_bf16 a[88:91], a[236:239], v[176:179], a[88:91]
    v_add_f32 v196, v196, v185
    v_add_f32 v196, v196, v186
    v_mfma_f32_16x16x32_bf16 a[92:95], a[236:239], v[180:183], a[92:95]
    s_waitcnt lgkmcnt(2)
    v_add_f32 v196, v196, v187
    v_cvt_pk_bf16_f32 v153, v186, v187
    v_mfma_f32_16x16x32_bf16 v[184:187], a[208:211], a[96:99], v[112:115]
    v_exp_f32 v188, v188
    v_mfma_f32_16x16x32_bf16 v[184:187], a[212:215], a[100:103], v[184:187]
    v_exp_f32 v189, v189
    v_mfma_f32_16x16x32_bf16 v[184:187], a[216:219], a[104:107], v[184:187]
    ds_read_b64_tr_b16 a[232:233], v208 offset:57344
    v_add_f32 v197, v197, v188
    v_mfma_f32_16x16x32_bf16 v[184:187], a[220:223], a[108:111], v[184:187]
    v_exp_f32 v190, v190
    v_mfma_f32_16x16x32_bf16 v[16:19], a[224:227], v[160:163], v[16:19]
    ds_read_b64_tr_b16 a[234:235], v208 offset:61440
    v_cvt_pk_bf16_f32 v156, v188, v189
    v_mfma_f32_16x16x32_bf16 v[20:23], a[224:227], v[164:167], v[20:23]
    v_exp_f32 v191, v191
    v_mfma_f32_16x16x32_bf16 v[24:27], a[224:227], v[168:171], v[24:27]
    v_add_f32 v197, v197, v189
    v_add_f32 v197, v197, v190
    v_mfma_f32_16x16x32_bf16 v[28:31], a[224:227], v[172:175], v[28:31]
    v_add_f32 v197, v197, v191
    v_cvt_pk_bf16_f32 v157, v190, v191
    v_mfma_f32_16x16x32_bf16 v[188:191], a[208:211], a[112:115], v[116:119]
    v_exp_f32 v184, v184
    v_mfma_f32_16x16x32_bf16 v[188:191], a[212:215], a[116:119], v[188:191]
    v_exp_f32 v185, v185
    v_mfma_f32_16x16x32_bf16 v[188:191], a[216:219], a[120:123], v[188:191]
    ds_read_b64_tr_b16 a[236:237], v209 offset:57344
    v_add_f32 v192, v192, v184
    v_mfma_f32_16x16x32_bf16 v[188:191], a[220:223], a[124:127], v[188:191]
    buffer_load_dwordx4 v214, s[84:87], 0 offen offset:2048 nt lds
    v_exp_f32 v186, v186
    v_mfma_f32_16x16x32_bf16 v[32:35], a[224:227], v[176:179], v[32:35]
    ds_read_b64_tr_b16 a[238:239], v209 offset:61440
    v_cvt_pk_bf16_f32 v138, v184, v185
    v_mfma_f32_16x16x32_bf16 v[36:39], a[224:227], v[180:183], v[36:39]
    s_waitcnt lgkmcnt(4)
    v_exp_f32 v187, v187
    v_mfma_f32_16x16x32_bf16 v[40:43], a[228:231], v[160:163], v[40:43]
    v_add_f32 v192, v192, v185
    v_add_f32 v192, v192, v186
    v_mfma_f32_16x16x32_bf16 v[44:47], a[228:231], v[164:167], v[44:47]
    v_add_f32 v192, v192, v187
    v_cvt_pk_bf16_f32 v139, v186, v187
    v_mfma_f32_16x16x32_bf16 v[184:187], a[208:211], a[128:131], v[120:123]
    v_exp_f32 v188, v188
    v_mfma_f32_16x16x32_bf16 v[184:187], a[212:215], a[132:135], v[184:187]
    v_exp_f32 v189, v189
    v_mfma_f32_16x16x32_bf16 v[184:187], a[216:219], a[136:139], v[184:187]
    ds_read_b128 a[192:195], v198 offset:61440
    v_add_f32 v193, v193, v188
    v_mfma_f32_16x16x32_bf16 v[184:187], a[220:223], a[140:143], v[184:187]
    buffer_load_dwordx4 v215, s[84:87], 0 offen offset:3072 nt lds
    v_exp_f32 v190, v190
    v_mfma_f32_16x16x32_bf16 v[48:51], a[228:231], v[168:171], v[48:51]
    ds_read_b128 a[196:199], v199 offset:61440
    v_cvt_pk_bf16_f32 v142, v188, v189
    v_mfma_f32_16x16x32_bf16 v[52:55], a[228:231], v[172:175], v[52:55]
    s_add_u32 s84, s84, 16384
    v_exp_f32 v191, v191
    v_mfma_f32_16x16x32_bf16 v[56:59], a[228:231], v[176:179], v[56:59]
    s_addc_u32 s85, s85, 0
    v_add_f32 v193, v193, v189
    v_add_f32 v193, v193, v190
    v_mfma_f32_16x16x32_bf16 v[60:63], a[228:231], v[180:183], v[60:63]
    s_sub_i32 s86, s86, 16384
    v_add_f32 v193, v193, v191
    v_cvt_pk_bf16_f32 v143, v190, v191
    v_mfma_f32_16x16x32_bf16 v[188:191], a[208:211], a[144:147], v[124:127]
    s_max_i32 s86, s86, 0
    v_exp_f32 v184, v184
    v_mfma_f32_16x16x32_bf16 v[188:191], a[212:215], a[148:151], v[188:191]
    v_exp_f32 v185, v185
    v_mfma_f32_16x16x32_bf16 v[188:191], a[216:219], a[152:155], v[188:191]
    ds_read_b128 a[200:203], v200 offset:61440
    v_add_f32 v194, v194, v184
    v_mfma_f32_16x16x32_bf16 v[188:191], a[220:223], a[156:159], v[188:191]
    s_waitcnt lgkmcnt(5)
    v_exp_f32 v186, v186
    v_mfma_f32_16x16x32_bf16 v[64:67], a[232:235], v[160:163], v[64:67]
    ds_read_b128 a[204:207], v201 offset:61440
    v_cvt_pk_bf16_f32 v146, v184, v185
    v_mfma_f32_16x16x32_bf16 v[68:71], a[232:235], v[164:167], v[68:71]
    v_exp_f32 v187, v187
    v_mfma_f32_16x16x32_bf16 v[72:75], a[232:235], v[168:171], v[72:75]
    v_add_f32 v194, v194, v185
    v_add_f32 v194, v194, v186
    v_mfma_f32_16x16x32_bf16 v[76:79], a[232:235], v[172:175], v[76:79]
    v_add_f32 v194, v194, v187
    v_cvt_pk_bf16_f32 v147, v186, v187
    v_mfma_f32_16x16x32_bf16 v[184:187], a[208:211], a[160:163], v[128:131]
    s_waitcnt vmcnt(16) lgkmcnt(0)
    v_exp_f32 v188, v188
    v_mfma_f32_16x16x32_bf16 v[184:187], a[212:215], a[164:167], v[184:187]
    s_barrier
    v_exp_f32 v189, v189
    v_mfma_f32_16x16x32_bf16 v[184:187], a[216:219], a[168:171], v[184:187]
    ds_read_b64_tr_b16 a[224:225], v202
    v_add_f32 v195, v195, v188
    v_mfma_f32_16x16x32_bf16 v[184:187], a[220:223], a[172:175], v[184:187]
    v_exp_f32 v190, v190
    v_mfma_f32_16x16x32_bf16 v[80:83], a[232:235], v[176:179], v[80:83]
    ds_read_b64_tr_b16 a[226:227], v202 offset:4096
    v_cvt_pk_bf16_f32 v150, v188, v189
    v_mfma_f32_16x16x32_bf16 v[84:87], a[232:235], v[180:183], v[84:87]
    v_exp_f32 v191, v191
    v_mfma_f32_16x16x32_bf16 v[88:91], a[236:239], v[160:163], v[88:91]
    v_add_f32 v195, v195, v189
    v_add_f32 v195, v195, v190
    v_mfma_f32_16x16x32_bf16 v[92:95], a[236:239], v[164:167], v[92:95]
    v_add_f32 v195, v195, v191
    v_cvt_pk_bf16_f32 v151, v190, v191
    v_mfma_f32_16x16x32_bf16 v[188:191], a[208:211], a[176:179], v[132:135]
    s_add_u32 s36, s36, 1
    v_exp_f32 v184, v184
    v_mfma_f32_16x16x32_bf16 v[188:191], a[212:215], a[180:183], v[188:191]
    v_exp_f32 v185, v185
    v_mfma_f32_16x16x32_bf16 v[188:191], a[216:219], a[184:187], v[188:191]
    ds_read_b64_tr_b16 a[228:229], v203
    v_add_f32 v196, v196, v184
    v_mfma_f32_16x16x32_bf16 v[188:191], a[220:223], a[188:191], v[188:191]
    v_exp_f32 v186, v186
    v_mfma_f32_16x16x32_bf16 v[96:99], a[236:239], v[168:171], v[96:99]
    ds_read_b64_tr_b16 a[230:231], v203 offset:4096
    v_cvt_pk_bf16_f32 v154, v184, v185
    v_mfma_f32_16x16x32_bf16 v[100:103], a[236:239], v[172:175], v[100:103]
    v_exp_f32 v187, v187
    v_mfma_f32_16x16x32_bf16 v[104:107], a[236:239], v[176:179], v[104:107]
    v_add_f32 v196, v196, v185
    v_add_f32 v196, v196, v186
    v_mfma_f32_16x16x32_bf16 v[108:111], a[236:239], v[180:183], v[108:111]
    v_add_f32 v196, v196, v187
    v_cvt_pk_bf16_f32 v155, v186, v187
    v_mfma_f32_16x16x32_bf16 v[184:187], a[192:195], a[96:99], v[112:115]
    v_exp_f32 v188, v188
    v_mfma_f32_16x16x32_bf16 v[184:187], a[196:199], a[100:103], v[184:187]
    v_exp_f32 v189, v189
    v_mfma_f32_16x16x32_bf16 v[184:187], a[200:203], a[104:107], v[184:187]
    ds_read_b64_tr_b16 a[232:233], v204
    v_add_f32 v197, v197, v188
    v_mfma_f32_16x16x32_bf16 v[184:187], a[204:207], a[108:111], v[184:187]
    s_waitcnt lgkmcnt(3)
    v_exp_f32 v190, v190
    v_mfma_f32_16x16x32_bf16 a[0:3], a[224:227], v[136:139], a[0:3]
    ds_read_b64_tr_b16 a[234:235], v204 offset:4096
    v_cvt_pk_bf16_f32 v158, v188, v189
    v_mfma_f32_16x16x32_bf16 a[4:7], a[224:227], v[140:143], a[4:7]
    v_exp_f32 v191, v191
    v_mfma_f32_16x16x32_bf16 a[8:11], a[224:227], v[144:147], a[8:11]
    v_add_f32 v197, v197, v189
    v_add_f32 v197, v197, v190
    v_mfma_f32_16x16x32_bf16 a[12:15], a[224:227], v[148:151], a[12:15]
    v_add_f32 v197, v197, v191
    v_cvt_pk_bf16_f32 v159, v190, v191
    v_mfma_f32_16x16x32_bf16 v[188:191], a[192:195], a[112:115], v[116:119]
    v_exp_f32 v184, v184
    v_mfma_f32_16x16x32_bf16 v[188:191], a[196:199], a[116:119], v[188:191]
    s_mov_b32 m0, s91
    v_exp_f32 v185, v185
    v_mfma_f32_16x16x32_bf16 v[188:191], a[200:203], a[120:123], v[188:191]
    ds_read_b64_tr_b16 a[236:237], v205
    v_add_f32 v192, v192, v184
    v_mfma_f32_16x16x32_bf16 v[188:191], a[204:207], a[124:127], v[188:191]
    buffer_load_dwordx4 v210, s[80:83], 0 offen nt lds
    v_exp_f32 v186, v186
    v_mfma_f32_16x16x32_bf16 a[16:19], a[224:227], v[152:155], a[16:19]
    ds_read_b64_tr_b16 a[238:239], v205 offset:4096
    v_cvt_pk_bf16_f32 v160, v184, v185
    v_mfma_f32_16x16x32_bf16 a[20:23], a[224:227], v[156:159], a[20:23]
    s_waitcnt lgkmcnt(4)
    v_exp_f32 v187, v187
    v_mfma_f32_16x16x32_bf16 a[24:27], a[228:231], v[136:139], a[24:27]
    v_add_f32 v192, v192, v185
    v_add_f32 v192, v192, v186
    v_mfma_f32_16x16x32_bf16 a[28:31], a[228:231], v[140:143], a[28:31]
    v_add_f32 v192, v192, v187
    v_cvt_pk_bf16_f32 v161, v186, v187
    v_mfma_f32_16x16x32_bf16 v[184:187], a[192:195], a[128:131], v[120:123]
    v_exp_f32 v188, v188
    v_mfma_f32_16x16x32_bf16 v[184:187], a[196:199], a[132:135], v[184:187]
    v_exp_f32 v189, v189
    v_mfma_f32_16x16x32_bf16 v[184:187], a[200:203], a[136:139], v[184:187]
    ds_read_b128 a[208:211], v198
    v_add_f32 v193, v193, v188
    v_mfma_f32_16x16x32_bf16 v[184:187], a[204:207], a[140:143], v[184:187]
    v_exp_f32 v190, v190
    v_mfma_f32_16x16x32_bf16 a[32:35], a[228:231], v[144:147], a[32:35]
    ds_read_b128 a[212:215], v199
    v_cvt_pk_bf16_f32 v164, v188, v189
    v_mfma_f32_16x16x32_bf16 a[36:39], a[228:231], v[148:151], a[36:39]
    v_exp_f32 v191, v191
    v_mfma_f32_16x16x32_bf16 a[40:43], a[228:231], v[152:155], a[40:43]
    v_add_f32 v193, v193, v189
    v_add_f32 v193, v193, v190
    v_mfma_f32_16x16x32_bf16 a[44:47], a[228:231], v[156:159], a[44:47]
    v_add_f32 v193, v193, v191
    v_cvt_pk_bf16_f32 v165, v190, v191
    v_mfma_f32_16x16x32_bf16 v[188:191], a[192:195], a[144:147], v[124:127]
    v_exp_f32 v184, v184
    v_mfma_f32_16x16x32_bf16 v[188:191], a[196:199], a[148:151], v[188:191]
    v_exp_f32 v185, v185
    v_mfma_f32_16x16x32_bf16 v[188:191], a[200:203], a[152:155], v[188:191]
    ds_read_b64_tr_b16 a[224:225], v206
    v_add_f32 v194, v194, v184
    v_mfma_f32_16x16x32_bf16 v[188:191], a[204:207], a[156:159], v[188:191]
    s_waitcnt lgkmcnt(5)
    v_exp_f32 v186, v186
    v_mfma_f32_16x16x32_bf16 a[48:51], a[232:235], v[136:139], a[48:51]
    ds_read_b64_tr_b16 a[226:227], v206 offset:4096
    v_cvt_pk_bf16_f32 v168, v184, v185
    v_mfma_f32_16x16x32_bf16 a[52:55], a[232:235], v[140:143], a[52:55]
    v_exp_f32 v187, v187
    v_mfma_f32_16x16x32_bf16 a[56:59], a[232:235], v[144:147], a[56:59]
    v_add_f32 v194, v194, v185
    v_add_f32 v194, v194, v186
    v_mfma_f32_16x16x32_bf16 a[60:63], a[232:235], v[148:151], a[60:63]
    v_add_f32 v194, v194, v187
    v_cvt_pk_bf16_f32 v169, v186, v187
    v_mfma_f32_16x16x32_bf16 v[184:187], a[192:195], a[160:163], v[128:131]
    v_exp_f32 v188, v188
    v_mfma_f32_16x16x32_bf16 v[184:187], a[196:199], a[164:167], v[184:187]
    v_exp_f32 v189, v189
    v_mfma_f32_16x16x32_bf16 v[184:187], a[200:203], a[168:171], v[184:187]
    ds_read_b128 a[216:219], v200
    v_add_f32 v195, v195, v188
    v_mfma_f32_16x16x32_bf16 v[184:187], a[204:207], a[172:175], v[184:187]
    buffer_load_dwordx4 v211, s[80:83], 0 offen offset:1024 nt lds
    v_exp_f32 v190, v190
    v_mfma_f32_16x16x32_bf16 a[64:67], a[232:235], v[152:155], a[64:67]
    ds_read_b128 a[220:223], v201
    v_cvt_pk_bf16_f32 v172, v188, v189
    v_mfma_f32_16x16x32_bf16 a[68:71], a[232:235], v[156:159], a[68:71]
    s_waitcnt lgkmcnt(6)
    v_exp_f32 v191, v191
    v_mfma_f32_16x16x32_bf16 a[72:75], a[236:239], v[136:139], a[72:75]
    v_add_f32 v195, v195, v189
    v_add_f32 v195, v195, v190
    v_mfma_f32_16x16x32_bf16 a[76:79], a[236:239], v[140:143], a[76:79]
    v_add_f32 v195, v195, v191
    v_cvt_pk_bf16_f32 v173, v190, v191
    v_mfma_f32_16x16x32_bf16 v[188:191], a[192:195], a[176:179], v[132:135]
    v_exp_f32 v184, v184
    v_mfma_f32_16x16x32_bf16 v[188:191], a[196:199], a[180:183], v[188:191]
    v_exp_f32 v185, v185
    v_mfma_f32_16x16x32_bf16 v[188:191], a[200:203], a[184:187], v[188:191]
    ds_read_b64_tr_b16 a[228:229], v207
    v_add_f32 v196, v196, v184
    v_mfma_f32_16x16x32_bf16 v[188:191], a[204:207], a[188:191], v[188:191]
    v_exp_f32 v186, v186
    v_mfma_f32_16x16x32_bf16 a[80:83], a[236:239], v[144:147], a[80:83]
    ds_read_b64_tr_b16 a[230:231], v207 offset:4096
    v_cvt_pk_bf16_f32 v176, v184, v185
    v_mfma_f32_16x16x32_bf16 a[84:87], a[236:239], v[148:151], a[84:87]
    v_exp_f32 v187, v187
    v_mfma_f32_16x16x32_bf16 a[88:91], a[236:239], v[152:155], a[88:91]
    v_add_f32 v196, v196, v185
    v_add_f32 v196, v196, v186
    v_mfma_f32_16x16x32_bf16 a[92:95], a[236:239], v[156:159], a[92:95]
    s_waitcnt lgkmcnt(2)
    v_add_f32 v196, v196, v187
    v_cvt_pk_bf16_f32 v177, v186, v187
    v_mfma_f32_16x16x32_bf16 v[184:187], a[208:211], a[96:99], v[112:115]
    v_exp_f32 v188, v188
    v_mfma_f32_16x16x32_bf16 v[184:187], a[212:215], a[100:103], v[184:187]
    v_exp_f32 v189, v189
    v_mfma_f32_16x16x32_bf16 v[184:187], a[216:219], a[104:107], v[184:187]
    ds_read_b64_tr_b16 a[232:233], v208
    v_add_f32 v197, v197, v188
    v_mfma_f32_16x16x32_bf16 v[184:187], a[220:223], a[108:111], v[184:187]
    v_exp_f32 v190, v190
    v_mfma_f32_16x16x32_bf16 v[16:19], a[224:227], v[136:139], v[16:19]
    ds_read_b64_tr_b16 a[234:235], v208 offset:4096
    v_cvt_pk_bf16_f32 v180, v188, v189
    v_mfma_f32_16x16x32_bf16 v[20:23], a[224:227], v[140:143], v[20:23]
    v_exp_f32 v191, v191
    v_mfma_f32_16x16x32_bf16 v[24:27], a[224:227], v[144:147], v[24:27]
    v_add_f32 v197, v197, v189
    v_add_f32 v197, v197, v190
    v_mfma_f32_16x16x32_bf16 v[28:31], a[224:227], v[148:151], v[28:31]
    v_add_f32 v197, v197, v191
    v_cvt_pk_bf16_f32 v181, v190, v191
    v_mfma_f32_16x16x32_bf16 v[188:191], a[208:211], a[112:115], v[116:119]
    v_exp_f32 v184, v184
    v_mfma_f32_16x16x32_bf16 v[188:191], a[212:215], a[116:119], v[188:191]
    v_exp_f32 v185, v185
    v_mfma_f32_16x16x32_bf16 v[188:191], a[216:219], a[120:123], v[188:191]
    ds_read_b64_tr_b16 a[236:237], v209
    v_add_f32 v192, v192, v184
    v_mfma_f32_16x16x32_bf16 v[188:191], a[220:223], a[124:127], v[188:191]
    buffer_load_dwordx4 v212, s[80:83], 0 offen offset:2048 nt lds
    v_exp_f32 v186, v186
    v_mfma_f32_16x16x32_bf16 v[32:35], a[224:227], v[152:155], v[32:35]
    ds_read_b64_tr_b16 a[238:239], v209 offset:4096
    v_cvt_pk_bf16_f32 v162, v184, v185
    v_mfma_f32_16x16x32_bf16 v[36:39], a[224:227], v[156:159], v[36:39]
    s_waitcnt lgkmcnt(4)
    v_exp_f32 v187, v187
    v_mfma_f32_16x16x32_bf16 v[40:43], a[228:231], v[136:139], v[40:43]
    v_add_f32 v192, v192, v185
    v_add_f32 v192, v192, v186
    v_mfma_f32_16x16x32_bf16 v[44:47], a[228:231], v[140:143], v[44:47]
    v_add_f32 v192, v192, v187
    v_cvt_pk_bf16_f32 v163, v186, v187
    v_mfma_f32_16x16x32_bf16 v[184:187], a[208:211], a[128:131], v[120:123]
    v_exp_f32 v188, v188
    v_mfma_f32_16x16x32_bf16 v[184:187], a[212:215], a[132:135], v[184:187]
    v_exp_f32 v189, v189
    v_mfma_f32_16x16x32_bf16 v[184:187], a[216:219], a[136:139], v[184:187]
    ds_read_b128 a[192:195], v198 offset:4096
    v_add_f32 v193, v193, v188
    v_mfma_f32_16x16x32_bf16 v[184:187], a[220:223], a[140:143], v[184:187]
    v_exp_f32 v190, v190
    v_mfma_f32_16x16x32_bf16 v[48:51], a[228:231], v[144:147], v[48:51]
    ds_read_b128 a[196:199], v199 offset:4096
    v_cvt_pk_bf16_f32 v166, v188, v189
    v_mfma_f32_16x16x32_bf16 v[52:55], a[228:231], v[148:151], v[52:55]
    v_exp_f32 v191, v191
    v_mfma_f32_16x16x32_bf16 v[56:59], a[228:231], v[152:155], v[56:59]
    v_add_f32 v193, v193, v189
    v_add_f32 v193, v193, v190
    v_mfma_f32_16x16x32_bf16 v[60:63], a[228:231], v[156:159], v[60:63]
    v_add_f32 v193, v193, v191
    v_cvt_pk_bf16_f32 v167, v190, v191
    v_mfma_f32_16x16x32_bf16 v[188:191], a[208:211], a[144:147], v[124:127]
    v_exp_f32 v184, v184
    v_mfma_f32_16x16x32_bf16 v[188:191], a[212:215], a[148:151], v[188:191]
    v_exp_f32 v185, v185
    v_mfma_f32_16x16x32_bf16 v[188:191], a[216:219], a[152:155], v[188:191]
    ds_read_b128 a[200:203], v200 offset:4096
    v_add_f32 v194, v194, v184
    v_mfma_f32_16x16x32_bf16 v[188:191], a[220:223], a[156:159], v[188:191]
    s_waitcnt lgkmcnt(5)
    v_exp_f32 v186, v186
    v_mfma_f32_16x16x32_bf16 v[64:67], a[232:235], v[136:139], v[64:67]
    ds_read_b128 a[204:207], v201 offset:4096
    v_cvt_pk_bf16_f32 v170, v184, v185
    v_mfma_f32_16x16x32_bf16 v[68:71], a[232:235], v[140:143], v[68:71]
    v_exp_f32 v187, v187
    v_mfma_f32_16x16x32_bf16 v[72:75], a[232:235], v[144:147], v[72:75]
    v_add_f32 v194, v194, v185
    v_add_f32 v194, v194, v186
    v_mfma_f32_16x16x32_bf16 v[76:79], a[232:235], v[148:151], v[76:79]
    v_add_f32 v194, v194, v187
    v_cvt_pk_bf16_f32 v171, v186, v187
    v_mfma_f32_16x16x32_bf16 v[184:187], a[208:211], a[160:163], v[128:131]
    v_exp_f32 v188, v188
    v_mfma_f32_16x16x32_bf16 v[184:187], a[212:215], a[164:167], v[184:187]
    v_exp_f32 v189, v189
    v_mfma_f32_16x16x32_bf16 v[184:187], a[216:219], a[168:171], v[184:187]
    ds_read_b64_tr_b16 a[224:225], v202 offset:8192
    v_add_f32 v195, v195, v188
    v_mfma_f32_16x16x32_bf16 v[184:187], a[220:223], a[172:175], v[184:187]
    buffer_load_dwordx4 v213, s[80:83], 0 offen offset:3072 nt lds
    v_exp_f32 v190, v190
    v_mfma_f32_16x16x32_bf16 v[80:83], a[232:235], v[152:155], v[80:83]
    ds_read_b64_tr_b16 a[226:227], v202 offset:12288
    v_cvt_pk_bf16_f32 v174, v188, v189
    v_mfma_f32_16x16x32_bf16 v[84:87], a[232:235], v[156:159], v[84:87]
    s_waitcnt lgkmcnt(6)
    v_exp_f32 v191, v191
    v_mfma_f32_16x16x32_bf16 v[88:91], a[236:239], v[136:139], v[88:91]
    s_add_u32 s80, s80, 16384
    v_add_f32 v195, v195, v189
    v_add_f32 v195, v195, v190
    v_mfma_f32_16x16x32_bf16 v[92:95], a[236:239], v[140:143], v[92:95]
    s_addc_u32 s81, s81, 0
    v_add_f32 v195, v195, v191
    v_cvt_pk_bf16_f32 v175, v190, v191
    v_mfma_f32_16x16x32_bf16 v[188:191], a[208:211], a[176:179], v[132:135]
    s_sub_i32 s82, s82, 16384
    v_exp_f32 v184, v184
    v_mfma_f32_16x16x32_bf16 v[188:191], a[212:215], a[180:183], v[188:191]
    s_max_i32 s82, s82, 0
    v_exp_f32 v185, v185
    v_mfma_f32_16x16x32_bf16 v[188:191], a[216:219], a[184:187], v[188:191]
    ds_read_b64_tr_b16 a[228:229], v203 offset:8192
    v_add_f32 v196, v196, v184
    v_mfma_f32_16x16x32_bf16 v[188:191], a[220:223], a[188:191], v[188:191]
    v_exp_f32 v186, v186
    v_mfma_f32_16x16x32_bf16 v[96:99], a[236:239], v[144:147], v[96:99]
    ds_read_b64_tr_b16 a[230:231], v203 offset:12288
    v_cvt_pk_bf16_f32 v178, v184, v185
    v_mfma_f32_16x16x32_bf16 v[100:103], a[236:239], v[148:151], v[100:103]
    v_exp_f32 v187, v187
    v_mfma_f32_16x16x32_bf16 v[104:107], a[236:239], v[152:155], v[104:107]
    v_add_f32 v196, v196, v185
    v_add_f32 v196, v196, v186
    v_mfma_f32_16x16x32_bf16 v[108:111], a[236:239], v[156:159], v[108:111]
    s_waitcnt lgkmcnt(4)
    v_add_f32 v196, v196, v187
    v_cvt_pk_bf16_f32 v179, v186, v187
    v_mfma_f32_16x16x32_bf16 v[184:187], a[192:195], a[96:99], v[112:115]
    v_exp_f32 v188, v188
    v_mfma_f32_16x16x32_bf16 v[184:187], a[196:199], a[100:103], v[184:187]
    v_exp_f32 v189, v189
    v_mfma_f32_16x16x32_bf16 v[184:187], a[200:203], a[104:107], v[184:187]
    ds_read_b64_tr_b16 a[232:233], v204 offset:8192
    v_add_f32 v197, v197, v188
    v_mfma_f32_16x16x32_bf16 v[184:187], a[204:207], a[108:111], v[184:187]
    s_waitcnt lgkmcnt(3)
    v_exp_f32 v190, v190
    v_mfma_f32_16x16x32_bf16 a[0:3], a[224:227], v[160:163], a[0:3]
    ds_read_b64_tr_b16 a[234:235], v204 offset:12288
    v_cvt_pk_bf16_f32 v182, v188, v189
    v_mfma_f32_16x16x32_bf16 a[4:7], a[224:227], v[164:167], a[4:7]
    v_exp_f32 v191, v191
    v_mfma_f32_16x16x32_bf16 a[8:11], a[224:227], v[168:171], a[8:11]
    v_add_f32 v197, v197, v189
    v_add_f32 v197, v197, v190
    v_mfma_f32_16x16x32_bf16 a[12:15], a[224:227], v[172:175], a[12:15]
    v_add_f32 v197, v197, v191
    v_cvt_pk_bf16_f32 v183, v190, v191
    v_mfma_f32_16x16x32_bf16 v[188:191], a[192:195], a[112:115], v[116:119]
    v_exp_f32 v184, v184
    v_mfma_f32_16x16x32_bf16 v[188:191], a[196:199], a[116:119], v[188:191]
    s_mov_b32 m0, s95
    v_exp_f32 v185, v185
    v_mfma_f32_16x16x32_bf16 v[188:191], a[200:203], a[120:123], v[188:191]
    ds_read_b64_tr_b16 a[236:237], v205 offset:8192
    v_add_f32 v192, v192, v184
    v_mfma_f32_16x16x32_bf16 v[188:191], a[204:207], a[124:127], v[188:191]
    buffer_load_dwordx4 v214, s[84:87], 0 offen nt lds
    v_exp_f32 v186, v186
    v_mfma_f32_16x16x32_bf16 a[16:19], a[224:227], v[176:179], a[16:19]
    ds_read_b64_tr_b16 a[238:239], v205 offset:12288
    v_cvt_pk_bf16_f32 v136, v184, v185
    v_mfma_f32_16x16x32_bf16 a[20:23], a[224:227], v[180:183], a[20:23]
    s_waitcnt lgkmcnt(4)
    v_exp_f32 v187, v187
    v_mfma_f32_16x16x32_bf16 a[24:27], a[228:231], v[160:163], a[24:27]
    v_add_f32 v192, v192, v185
    v_add_f32 v192, v192, v186
    v_mfma_f32_16x16x32_bf16 a[28:31], a[228:231], v[164:167], a[28:31]
    v_add_f32 v192, v192, v187
    v_cvt_pk_bf16_f32 v137, v186, v187
    v_mfma_f32_16x16x32_bf16 v[184:187], a[192:195], a[128:131], v[120:123]
    v_exp_f32 v188, v188
    v_mfma_f32_16x16x32_bf16 v[184:187], a[196:199], a[132:135], v[184:187]
    v_exp_f32 v189, v189
    v_mfma_f32_16x16x32_bf16 v[184:187], a[200:203], a[136:139], v[184:187]
    ds_read_b128 a[208:211], v198 offset:8192
    v_add_f32 v193, v193, v188
    v_mfma_f32_16x16x32_bf16 v[184:187], a[204:207], a[140:143], v[184:187]
    v_exp_f32 v190, v190
    v_mfma_f32_16x16x32_bf16 a[32:35], a[228:231], v[168:171], a[32:35]
    ds_read_b128 a[212:215], v199 offset:8192
    v_cvt_pk_bf16_f32 v140, v188, v189
    v_mfma_f32_16x16x32_bf16 a[36:39], a[228:231], v[172:175], a[36:39]
    v_exp_f32 v191, v191
    v_mfma_f32_16x16x32_bf16 a[40:43], a[228:231], v[176:179], a[40:43]
    v_add_f32 v193, v193, v189
    v_add_f32 v193, v193, v190
    v_mfma_f32_16x16x32_bf16 a[44:47], a[228:231], v[180:183], a[44:47]
    v_add_f32 v193, v193, v191
    v_cvt_pk_bf16_f32 v141, v190, v191
    v_mfma_f32_16x16x32_bf16 v[188:191], a[192:195], a[144:147], v[124:127]
    v_exp_f32 v184, v184
    v_mfma_f32_16x16x32_bf16 v[188:191], a[196:199], a[148:151], v[188:191]
    v_exp_f32 v185, v185
    v_mfma_f32_16x16x32_bf16 v[188:191], a[200:203], a[152:155], v[188:191]
    ds_read_b64_tr_b16 a[224:225], v206 offset:8192
    v_add_f32 v194, v194, v184
    v_mfma_f32_16x16x32_bf16 v[188:191], a[204:207], a[156:159], v[188:191]
    s_waitcnt lgkmcnt(5)
    v_exp_f32 v186, v186
    v_mfma_f32_16x16x32_bf16 a[48:51], a[232:235], v[160:163], a[48:51]
    ds_read_b64_tr_b16 a[226:227], v206 offset:12288
    v_cvt_pk_bf16_f32 v144, v184, v185
    v_mfma_f32_16x16x32_bf16 a[52:55], a[232:235], v[164:167], a[52:55]
    v_exp_f32 v187, v187
    v_mfma_f32_16x16x32_bf16 a[56:59], a[232:235], v[168:171], a[56:59]
    v_add_f32 v194, v194, v185
    v_add_f32 v194, v194, v186
    v_mfma_f32_16x16x32_bf16 a[60:63], a[232:235], v[172:175], a[60:63]
    v_add_f32 v194, v194, v187
    v_cvt_pk_bf16_f32 v145, v186, v187
    v_mfma_f32_16x16x32_bf16 v[184:187], a[192:195], a[160:163], v[128:131]
    v_exp_f32 v188, v188
    v_mfma_f32_16x16x32_bf16 v[184:187], a[196:199], a[164:167], v[184:187]
    v_exp_f32 v189, v189
    v_mfma_f32_16x16x32_bf16 v[184:187], a[200:203], a[168:171], v[184:187]
    ds_read_b128 a[216:219], v200 offset:8192
    v_add_f32 v195, v195, v188
    v_mfma_f32_16x16x32_bf16 v[184:187], a[204:207], a[172:175], v[184:187]
    buffer_load_dwordx4 v215, s[84:87], 0 offen offset:1024 nt lds
    v_exp_f32 v190, v190
    v_mfma_f32_16x16x32_bf16 a[64:67], a[232:235], v[176:179], a[64:67]
    ds_read_b128 a[220:223], v201 offset:8192
    v_cvt_pk_bf16_f32 v148, v188, v189
    v_mfma_f32_16x16x32_bf16 a[68:71], a[232:235], v[180:183], a[68:71]
    s_waitcnt lgkmcnt(6)
    v_exp_f32 v191, v191
    v_mfma_f32_16x16x32_bf16 a[72:75], a[236:239], v[160:163], a[72:75]
    v_add_f32 v195, v195, v189
    v_add_f32 v195, v195, v190
    v_mfma_f32_16x16x32_bf16 a[76:79], a[236:239], v[164:167], a[76:79]
    v_add_f32 v195, v195, v191
    v_cvt_pk_bf16_f32 v149, v190, v191
    v_mfma_f32_16x16x32_bf16 v[188:191], a[192:195], a[176:179], v[132:135]
    v_exp_f32 v184, v184
    v_mfma_f32_16x16x32_bf16 v[188:191], a[196:199], a[180:183], v[188:191]
    v_exp_f32 v185, v185
    v_mfma_f32_16x16x32_bf16 v[188:191], a[200:203], a[184:187], v[188:191]
    ds_read_b64_tr_b16 a[228:229], v207 offset:8192
    v_add_f32 v196, v196, v184
    v_mfma_f32_16x16x32_bf16 v[188:191], a[204:207], a[188:191], v[188:191]
    v_exp_f32 v186, v186
    v_mfma_f32_16x16x32_bf16 a[80:83], a[236:239], v[168:171], a[80:83]
    ds_read_b64_tr_b16 a[230:231], v207 offset:12288
    v_cvt_pk_bf16_f32 v152, v184, v185
    v_mfma_f32_16x16x32_bf16 a[84:87], a[236:239], v[172:175], a[84:87]
    v_exp_f32 v187, v187
    v_mfma_f32_16x16x32_bf16 a[88:91], a[236:239], v[176:179], a[88:91]
    v_add_f32 v196, v196, v185
    v_add_f32 v196, v196, v186
    v_mfma_f32_16x16x32_bf16 a[92:95], a[236:239], v[180:183], a[92:95]
    s_waitcnt lgkmcnt(2)
    v_add_f32 v196, v196, v187
    v_cvt_pk_bf16_f32 v153, v186, v187
    v_mfma_f32_16x16x32_bf16 v[184:187], a[208:211], a[96:99], v[112:115]
    v_exp_f32 v188, v188
    v_mfma_f32_16x16x32_bf16 v[184:187], a[212:215], a[100:103], v[184:187]
    v_exp_f32 v189, v189
    v_mfma_f32_16x16x32_bf16 v[184:187], a[216:219], a[104:107], v[184:187]
    ds_read_b64_tr_b16 a[232:233], v208 offset:8192
    v_add_f32 v197, v197, v188
    v_mfma_f32_16x16x32_bf16 v[184:187], a[220:223], a[108:111], v[184:187]
    v_exp_f32 v190, v190
    v_mfma_f32_16x16x32_bf16 v[16:19], a[224:227], v[160:163], v[16:19]
    ds_read_b64_tr_b16 a[234:235], v208 offset:12288
    v_cvt_pk_bf16_f32 v156, v188, v189
    v_mfma_f32_16x16x32_bf16 v[20:23], a[224:227], v[164:167], v[20:23]
    v_exp_f32 v191, v191
    v_mfma_f32_16x16x32_bf16 v[24:27], a[224:227], v[168:171], v[24:27]
    v_add_f32 v197, v197, v189
    v_add_f32 v197, v197, v190
    v_mfma_f32_16x16x32_bf16 v[28:31], a[224:227], v[172:175], v[28:31]
    v_add_f32 v197, v197, v191
    v_cvt_pk_bf16_f32 v157, v190, v191
    v_mfma_f32_16x16x32_bf16 v[188:191], a[208:211], a[112:115], v[116:119]
    v_exp_f32 v184, v184
    v_mfma_f32_16x16x32_bf16 v[188:191], a[212:215], a[116:119], v[188:191]
    v_exp_f32 v185, v185
    v_mfma_f32_16x16x32_bf16 v[188:191], a[216:219], a[120:123], v[188:191]
    ds_read_b64_tr_b16 a[236:237], v209 offset:8192
    v_add_f32 v192, v192, v184
    v_mfma_f32_16x16x32_bf16 v[188:191], a[220:223], a[124:127], v[188:191]
    buffer_load_dwordx4 v214, s[84:87], 0 offen offset:2048 nt lds
    v_exp_f32 v186, v186
    v_mfma_f32_16x16x32_bf16 v[32:35], a[224:227], v[176:179], v[32:35]
    ds_read_b64_tr_b16 a[238:239], v209 offset:12288
    v_cvt_pk_bf16_f32 v138, v184, v185
    v_mfma_f32_16x16x32_bf16 v[36:39], a[224:227], v[180:183], v[36:39]
    s_waitcnt lgkmcnt(4)
    v_exp_f32 v187, v187
    v_mfma_f32_16x16x32_bf16 v[40:43], a[228:231], v[160:163], v[40:43]
    v_add_f32 v192, v192, v185
    v_add_f32 v192, v192, v186
    v_mfma_f32_16x16x32_bf16 v[44:47], a[228:231], v[164:167], v[44:47]
    v_add_f32 v192, v192, v187
    v_cvt_pk_bf16_f32 v139, v186, v187
    v_mfma_f32_16x16x32_bf16 v[184:187], a[208:211], a[128:131], v[120:123]
    v_exp_f32 v188, v188
    v_mfma_f32_16x16x32_bf16 v[184:187], a[212:215], a[132:135], v[184:187]
    v_exp_f32 v189, v189
    v_mfma_f32_16x16x32_bf16 v[184:187], a[216:219], a[136:139], v[184:187]
    ds_read_b128 a[192:195], v198 offset:12288
    v_add_f32 v193, v193, v188
    v_mfma_f32_16x16x32_bf16 v[184:187], a[220:223], a[140:143], v[184:187]
    buffer_load_dwordx4 v215, s[84:87], 0 offen offset:3072 nt lds
    v_exp_f32 v190, v190
    v_mfma_f32_16x16x32_bf16 v[48:51], a[228:231], v[168:171], v[48:51]
    ds_read_b128 a[196:199], v199 offset:12288
    v_cvt_pk_bf16_f32 v142, v188, v189
    v_mfma_f32_16x16x32_bf16 v[52:55], a[228:231], v[172:175], v[52:55]
    s_add_u32 s84, s84, 16384
    v_exp_f32 v191, v191
    v_mfma_f32_16x16x32_bf16 v[56:59], a[228:231], v[176:179], v[56:59]
    s_addc_u32 s85, s85, 0
    v_add_f32 v193, v193, v189
    v_add_f32 v193, v193, v190
    v_mfma_f32_16x16x32_bf16 v[60:63], a[228:231], v[180:183], v[60:63]
    s_sub_i32 s86, s86, 16384
    v_add_f32 v193, v193, v191
    v_cvt_pk_bf16_f32 v143, v190, v191
    v_mfma_f32_16x16x32_bf16 v[188:191], a[208:211], a[144:147], v[124:127]
    s_max_i32 s86, s86, 0
    v_exp_f32 v184, v184
    v_mfma_f32_16x16x32_bf16 v[188:191], a[212:215], a[148:151], v[188:191]
    v_exp_f32 v185, v185
    v_mfma_f32_16x16x32_bf16 v[188:191], a[216:219], a[152:155], v[188:191]
    ds_read_b128 a[200:203], v200 offset:12288
    v_add_f32 v194, v194, v184
    v_mfma_f32_16x16x32_bf16 v[188:191], a[220:223], a[156:159], v[188:191]
    s_waitcnt lgkmcnt(5)
    v_exp_f32 v186, v186
    v_mfma_f32_16x16x32_bf16 v[64:67], a[232:235], v[160:163], v[64:67]
    ds_read_b128 a[204:207], v201 offset:12288
    v_cvt_pk_bf16_f32 v146, v184, v185
    v_mfma_f32_16x16x32_bf16 v[68:71], a[232:235], v[164:167], v[68:71]
    v_exp_f32 v187, v187
    v_mfma_f32_16x16x32_bf16 v[72:75], a[232:235], v[168:171], v[72:75]
    v_add_f32 v194, v194, v185
    v_add_f32 v194, v194, v186
    v_mfma_f32_16x16x32_bf16 v[76:79], a[232:235], v[172:175], v[76:79]
    v_add_f32 v194, v194, v187
    v_cvt_pk_bf16_f32 v147, v186, v187
    v_mfma_f32_16x16x32_bf16 v[184:187], a[208:211], a[160:163], v[128:131]
    s_waitcnt vmcnt(16) lgkmcnt(0)
    v_exp_f32 v188, v188
    v_mfma_f32_16x16x32_bf16 v[184:187], a[212:215], a[164:167], v[184:187]
    s_barrier
    v_exp_f32 v189, v189
    v_mfma_f32_16x16x32_bf16 v[184:187], a[216:219], a[168:171], v[184:187]
    ds_read_b64_tr_b16 a[224:225], v202 offset:16384
    v_add_f32 v195, v195, v188
    v_mfma_f32_16x16x32_bf16 v[184:187], a[220:223], a[172:175], v[184:187]
    v_exp_f32 v190, v190
    v_mfma_f32_16x16x32_bf16 v[80:83], a[232:235], v[176:179], v[80:83]
    ds_read_b64_tr_b16 a[226:227], v202 offset:20480
    v_cvt_pk_bf16_f32 v150, v188, v189
    v_mfma_f32_16x16x32_bf16 v[84:87], a[232:235], v[180:183], v[84:87]
    v_exp_f32 v191, v191
    v_mfma_f32_16x16x32_bf16 v[88:91], a[236:239], v[160:163], v[88:91]
    v_add_f32 v195, v195, v189
    v_add_f32 v195, v195, v190
    v_mfma_f32_16x16x32_bf16 v[92:95], a[236:239], v[164:167], v[92:95]
    v_add_f32 v195, v195, v191
    v_cvt_pk_bf16_f32 v151, v190, v191
    v_mfma_f32_16x16x32_bf16 v[188:191], a[208:211], a[176:179], v[132:135]
    v_exp_f32 v184, v184
    v_mfma_f32_16x16x32_bf16 v[188:191], a[212:215], a[180:183], v[188:191]
    v_exp_f32 v185, v185
    v_mfma_f32_16x16x32_bf16 v[188:191], a[216:219], a[184:187], v[188:191]
    ds_read_b64_tr_b16 a[228:229], v203 offset:16384
    v_add_f32 v196, v196, v184
    v_mfma_f32_16x16x32_bf16 v[188:191], a[220:223], a[188:191], v[188:191]
    v_exp_f32 v186, v186
    v_mfma_f32_16x16x32_bf16 v[96:99], a[236:239], v[168:171], v[96:99]
    ds_read_b64_tr_b16 a[230:231], v203 offset:20480
    v_cvt_pk_bf16_f32 v154, v184, v185
    v_mfma_f32_16x16x32_bf16 v[100:103], a[236:239], v[172:175], v[100:103]
    v_exp_f32 v187, v187
    v_mfma_f32_16x16x32_bf16 v[104:107], a[236:239], v[176:179], v[104:107]
    v_add_f32 v196, v196, v185
    v_add_f32 v196, v196, v186
    v_mfma_f32_16x16x32_bf16 v[108:111], a[236:239], v[180:183], v[108:111]
    v_add_f32 v196, v196, v187
    v_cvt_pk_bf16_f32 v155, v186, v187
    s_branch L_loop
L_tail:
    v_mfma_f32_16x16x32_bf16 v[184:187], a[192:195], a[96:99], v[112:115]
    v_exp_f32 v188, v188
    v_mfma_f32_16x16x32_bf16 v[184:187], a[196:199], a[100:103], v[184:187]
    ds_read_b128 a[208:211], v198 offset:49152
    v_exp_f32 v189, v189
    v_mfma_f32_16x16x32_bf16 v[184:187], a[200:203], a[104:107], v[184:187]
    ds_read_b128 a[212:215], v199 offset:49152
    v_add_f32 v197, v197, v188
    v_cvt_pk_bf16_f32 v158, v188, v189
    v_mfma_f32_16x16x32_bf16 v[184:187], a[204:207], a[108:111], v[184:187]
    ds_read_b128 a[216:219], v200 offset:49152
    v_exp_f32 v190, v190
    v_exp_f32 v191, v191
    v_add_f32 v197, v197, v189
    v_add_f32 v197, v197, v190
    v_add_f32 v197, v197, v191
    v_cvt_pk_bf16_f32 v159, v190, v191
    v_mfma_f32_16x16x32_bf16 v[188:191], a[192:195], a[112:115], v[116:119]
    v_exp_f32 v184, v184
    v_mfma_f32_16x16x32_bf16 v[188:191], a[196:199], a[116:119], v[188:191]
    ds_read_b128 a[220:223], v201 offset:49152
    v_exp_f32 v185, v185
    v_mfma_f32_16x16x32_bf16 v[188:191], a[200:203], a[120:123], v[188:191]
    ds_read_b64_tr_b16 a[232:233], v204 offset:49152
    v_add_f32 v192, v192, v184
    v_cvt_pk_bf16_f32 v160, v184, v185
    v_mfma_f32_16x16x32_bf16 v[188:191], a[204:207], a[124:127], v[188:191]
    ds_read_b64_tr_b16 a[234:235], v204 offset:53248
    v_exp_f32 v186, v186
    v_exp_f32 v187, v187
    v_add_f32 v192, v192, v185
    v_add_f32 v192, v192, v186
    v_add_f32 v192, v192, v187
    v_cvt_pk_bf16_f32 v161, v186, v187
    v_mfma_f32_16x16x32_bf16 v[184:187], a[192:195], a[128:131], v[120:123]
    v_exp_f32 v188, v188
    v_mfma_f32_16x16x32_bf16 v[184:187], a[196:199], a[132:135], v[184:187]
    ds_read_b64_tr_b16 a[236:237], v205 offset:49152
    v_exp_f32 v189, v189
    v_mfma_f32_16x16x32_bf16 v[184:187], a[200:203], a[136:139], v[184:187]
    ds_read_b64_tr_b16 a[238:239], v205 offset:53248
    v_add_f32 v193, v193, v188
    v_cvt_pk_bf16_f32 v164, v188, v189
    v_mfma_f32_16x16x32_bf16 v[184:187], a[204:207], a[140:143], v[184:187]
    ds_read_b64_tr_b16 a[240:241], v206 offset:49152
    v_exp_f32 v190, v190
    v_exp_f32 v191, v191
    v_add_f32 v193, v193, v189
    v_add_f32 v193, v193, v190
    v_add_f32 v193, v193, v191
    v_cvt_pk_bf16_f32 v165, v190, v191
    v_mfma_f32_16x16x32_bf16 v[188:191], a[192:195], a[144:147], v[124:127]
    v_exp_f32 v184, v184
    v_mfma_f32_16x16x32_bf16 v[188:191], a[196:199], a[148:151], v[188:191]
    ds_read_b64_tr_b16 a[242:243], v206 offset:53248
    v_exp_f32 v185, v185
    v_mfma_f32_16x16x32_bf16 v[188:191], a[200:203], a[152:155], v[188:191]
    ds_read_b64_tr_b16 a[244:245], v207 offset:49152
    v_add_f32 v194, v194, v184
    v_cvt_pk_bf16_f32 v168, v184, v185
    v_mfma_f32_16x16x32_bf16 v[188:191], a[204:207], a[156:159], v[188:191]
    ds_read_b64_tr_b16 a[246:247], v207 offset:53248
    v_exp_f32 v186, v186
    v_exp_f32 v187, v187
    v_add_f32 v194, v194, v185
    v_add_f32 v194, v194, v186
    v_add_f32 v194, v194, v187
    v_cvt_pk_bf16_f32 v169, v186, v187
    v_mfma_f32_16x16x32_bf16 v[184:187], a[192:195], a[160:163], v[128:131]
    v_exp_f32 v188, v188
    v_mfma_f32_16x16x32_bf16 v[184:187], a[196:199], a[164:167], v[184:187]
    ds_read_b64_tr_b16 a[248:249], v208 offset:49152
    v_exp_f32 v189, v189
    v_mfma_f32_16x16x32_bf16 v[184:187], a[200:203], a[168:171], v[184:187]
    ds_read_b64_tr_b16 a[250:251], v208 offset:53248
    v_add_f32 v195, v195, v188
    v_cvt_pk_bf16_f32 v172, v188, v189
    v_mfma_f32_16x16x32_bf16 v[184:187], a[204:207], a[172:175], v[184:187]
    ds_read_b64_tr_b16 a[252:253], v209 offset:49152
    v_exp_f32 v190, v190
    v_exp_f32 v191, v191
    v_add_f32 v195, v195, v189
    v_add_f32 v195, v195, v190
    v_add_f32 v195, v195, v191
    v_cvt_pk_bf16_f32 v173, v190, v191
    v_mfma_f32_16x16x32_bf16 v[188:191], a[192:195], a[176:179], v[132:135]
    v_exp_f32 v184, v184
    v_mfma_f32_16x16x32_bf16 v[188:191], a[196:199], a[180:183], v[188:191]
    ds_read_b64_tr_b16 a[254:255], v209 offset:53248
    v_exp_f32 v185, v185
    v_mfma_f32_16x16x32_bf16 v[188:191], a[200:203], a[184:187], v[188:191]
    ds_read_b64_tr_b16 v[218:219], v202 offset:57344
    v_add_f32 v196, v196, v184
    v_cvt_pk_bf16_f32 v176, v184, v185
    v_mfma_f32_16x16x32_bf16 v[188:191], a[204:207], a[188:191], v[188:191]
    v_exp_f32 v186, v186
    s_waitcnt lgkmcnt(13)
    v_exp_f32 v187, v187
    v_add_f32 v196, v196, v185
    v_add_f32 v196, v196, v186
    v_add_f32 v196, v196, v187
    v_cvt_pk_bf16_f32 v177, v186, v187
    v_mfma_f32_16x16x32_bf16 v[184:187], a[208:211], a[96:99], v[112:115]
    v_exp_f32 v188, v188
    v_mfma_f32_16x16x32_bf16 v[184:187], a[212:215], a[100:103], v[184:187]
    ds_read_b64_tr_b16 v[220:221], v202 offset:61440
    v_exp_f32 v189, v189
    v_mfma_f32_16x16x32_bf16 v[184:187], a[216:219], a[104:107], v[184:187]
    ds_read_b64_tr_b16 v[222:223], v203 offset:57344
    v_add_f32 v197, v197, v188
    v_cvt_pk_bf16_f32 v180, v188, v189
    v_mfma_f32_16x16x32_bf16 v[184:187], a[220:223], a[108:111], v[184:187]
    ds_read_b64_tr_b16 v[224:225], v203 offset:61440
    v_exp_f32 v190, v190
    v_exp_f32 v191, v191
    v_add_f32 v197, v197, v189
    v_add_f32 v197, v197, v190
    v_add_f32 v197, v197, v191
    v_cvt_pk_bf16_f32 v181, v190, v191
    v_mfma_f32_16x16x32_bf16 v[188:191], a[208:211], a[112:115], v[116:119]
    v_exp_f32 v184, v184
    v_mfma_f32_16x16x32_bf16 v[188:191], a[212:215], a[116:119], v[188:191]
    ds_read_b64_tr_b16 v[226:227], v204 offset:57344
    v_exp_f32 v185, v185
    v_mfma_f32_16x16x32_bf16 v[188:191], a[216:219], a[120:123], v[188:191]
    ds_read_b64_tr_b16 v[228:229], v204 offset:61440
    v_add_f32 v192, v192, v184
    v_cvt_pk_bf16_f32 v162, v184, v185
    v_mfma_f32_16x16x32_bf16 v[188:191], a[220:223], a[124:127], v[188:191]
    ds_read_b64_tr_b16 v[230:231], v205 offset:57344
    v_exp_f32 v186, v186
    v_exp_f32 v187, v187
    v_add_f32 v192, v192, v185
    v_add_f32 v192, v192, v186
    v_add_f32 v192, v192, v187
    v_cvt_pk_bf16_f32 v163, v186, v187
    v_mfma_f32_16x16x32_bf16 v[184:187], a[208:211], a[128:131], v[120:123]
    v_exp_f32 v188, v188
    v_mfma_f32_16x16x32_bf16 v[184:187], a[212:215], a[132:135], v[184:187]
    ds_read_b64_tr_b16 v[232:233], v205 offset:61440
    v_exp_f32 v189, v189
    v_mfma_f32_16x16x32_bf16 v[184:187], a[216:219], a[136:139], v[184:187]
    ds_read_b64_tr_b16 v[234:235], v206 offset:57344
    v_add_f32 v193, v193, v188
    v_cvt_pk_bf16_f32 v166, v188, v189
    v_mfma_f32_16x16x32_bf16 v[184:187], a[220:223], a[140:143], v[184:187]
    ds_read_b64_tr_b16 v[236:237], v206 offset:61440
    v_exp_f32 v190, v190
    v_exp_f32 v191, v191
    v_add_f32 v193, v193, v189
    v_add_f32 v193, v193, v190
    v_add_f32 v193, v193, v191
    v_cvt_pk_bf16_f32 v167, v190, v191
    v_mfma_f32_16x16x32_bf16 v[188:191], a[208:211], a[144:147], v[124:127]
    v_exp_f32 v184, v184
    v_mfma_f32_16x16x32_bf16 v[188:191], a[212:215], a[148:151], v[188:191]
    ds_read_b64_tr_b16 v[238:239], v207 offset:57344
    v_exp_f32 v185, v185
    v_mfma_f32_16x16x32_bf16 v[188:191], a[216:219], a[152:155], v[188:191]
    ds_read_b64_tr_b16 v[240:241], v207 offset:61440
    v_add_f32 v194, v194, v184
    v_cvt_pk_bf16_f32 v170, v184, v185
    v_mfma_f32_16x16x32_bf16 v[188:191], a[220:223], a[156:159], v[188:191]
    ds_read_b64_tr_b16 v[242:243], v208 offset:57344
    v_exp_f32 v186, v186
    v_exp_f32 v187, v187
    v_add_f32 v194, v194, v185
    v_add_f32 v194, v194, v186
    v_add_f32 v194, v194, v187
    v_cvt_pk_bf16_f32 v171, v186, v187
    v_mfma_f32_16x16x32_bf16 v[184:187], a[208:211], a[160:163], v[128:131]
    v_exp_f32 v188, v188
    v_mfma_f32_16x16x32_bf16 v[184:187], a[212:215], a[164:167], v[184:187]
    ds_read_b64_tr_b16 v[244:245], v208 offset:61440
    v_exp_f32 v189, v189
    v_mfma_f32_16x16x32_bf16 v[184:187], a[216:219], a[168:171], v[184:187]
    ds_read_b64_tr_b16 v[246:247], v209 offset:57344
    v_add_f32 v195, v195, v188
    v_cvt_pk_bf16_f32 v174, v188, v189
    v_mfma_f32_16x16x32_bf16 v[184:187], a[220:223], a[172:175], v[184:187]
    ds_read_b64_tr_b16 v[248:249], v209 offset:61440
    v_exp_f32 v190, v190
    v_exp_f32 v191, v191
    v_add_f32 v195, v195, v189
    v_add_f32 v195, v195, v190
    v_add_f32 v195, v195, v191
    v_cvt_pk_bf16_f32 v175, v190, v191
    v_mfma_f32_16x16x32_bf16 v[188:191], a[208:211], a[176:179], v[132:135]
    v_exp_f32 v184, v184
    v_mfma_f32_16x16x32_bf16 v[188:191], a[212:215], a[180:183], v[188:191]
    v_exp_f32 v185, v185
    v_mfma_f32_16x16x32_bf16 v[188:191], a[216:219], a[184:187], v[188:191]
    v_add_f32 v196, v196, v184
    v_cvt_pk_bf16_f32 v178, v184, v185
    v_mfma_f32_16x16x32_bf16 v[188:191], a[220:223], a[188:191], v[188:191]
    v_exp_f32 v186, v186
    v_exp_f32 v187, v187
    v_add_f32 v196, v196, v185
    v_add_f32 v196, v196, v186
    v_add_f32 v196, v196, v187
    v_cvt_pk_bf16_f32 v179, v186, v187
    s_mov_b64 s[48:49], 0
    s_waitcnt lgkmcnt(0)
    v_mfma_f32_16x16x32_bf16 a[0:3], a[224:227], v[136:139], a[0:3]
    v_exp_f32 v188, v188
    v_mfma_f32_16x16x32_bf16 a[0:3], v[218:221], v[160:163], a[0:3]
    v_exp_f32 v189, v189
    v_accvgpr_write_b32 a208, 0
    v_mfma_f32_16x16x32_bf16 a[24:27], a[228:231], v[136:139], a[24:27]
    v_add_f32 v197, v197, v188
    v_exp_f32 v190, v190
    v_mfma_f32_16x16x32_bf16 a[24:27], v[222:225], v[160:163], a[24:27]
    v_accvgpr_write_b32 a209, 0
    v_cvt_pk_bf16_f32 v182, v188, v189
    v_mfma_f32_16x16x32_bf16 a[48:51], a[232:235], v[136:139], a[48:51]
    v_add_f32 v197, v197, v189
    v_exp_f32 v191, v191
    v_mfma_f32_16x16x32_bf16 a[48:51], v[226:229], v[160:163], a[48:51]
    v_accvgpr_write_b32 a210, 0
    v_add_f32 v197, v197, v190
    v_mfma_f32_16x16x32_bf16 a[72:75], a[236:239], v[136:139], a[72:75]
    v_accvgpr_write_b32 a211, 0
    v_add_f32 v197, v197, v191
    v_mfma_f32_16x16x32_bf16 a[72:75], v[230:233], v[160:163], a[72:75]
    v_cvt_pk_bf16_f32 v183, v190, v191
    v_mov_b32 v132, 0
    v_mfma_f32_16x16x32_bf16 v[16:19], a[240:243], v[136:139], v[16:19]
    v_mov_b32 v133, 0
    v_mfma_f32_16x16x32_bf16 v[16:19], v[234:237], v[160:163], v[16:19]
    v_mov_b32 v134, 0
    v_mov_b32 v135, 0
    v_mfma_f32_16x16x32_bf16 v[40:43], a[244:247], v[136:139], v[40:43]
    v_mov_b32 v184, v192
    s_nop 1
    v_mfma_f32_16x16x32_bf16 v[40:43], v[238:241], v[160:163], v[40:43]
    v_permlane32_swap_b32 v192, v184
    v_add_f32 v192, v192, v184
    v_mfma_f32_16x16x32_bf16 v[64:67], a[248:251], v[136:139], v[64:67]
    v_mov_b32 v184, v192
    s_nop 1
    v_mfma_f32_16x16x32_bf16 v[64:67], v[242:245], v[160:163], v[64:67]
    v_permlane16_swap_b32 v192, v184
    v_add_f32 v192, v192, v184
    v_mfma_f32_16x16x32_bf16 v[88:91], a[252:255], v[136:139], v[88:91]
    v_cmp_ngt_f32 vcc, s50, v192
    v_rcp_f32 v192, v192
    v_mfma_f32_16x16x32_bf16 v[88:91], v[246:249], v[160:163], v[88:91]
    s_nop 0
    s_or_b64 s[48:49], s[48:49], vcc
    v_mfma_f32_16x16x32_bf16 a[4:7], a[224:227], v[140:143], a[4:7]
    v_accvgpr_read_b32 v112, a0
    v_accvgpr_read_b32 v113, a1
    v_accvgpr_read_b32 v114, a2
    v_accvgpr_read_b32 v115, a3
    v_mul_f32 v112, v112, v192
    v_mul_f32 v113, v113, v192
    v_mfma_f32_16x16x32_bf16 a[4:7], v[218:221], v[164:167], a[4:7]
    v_mul_f32 v114, v114, v192
    v_mul_f32 v115, v115, v192
    v_cvt_pk_bf16_f32 v124, v112, v113
    v_cvt_pk_bf16_f32 v125, v114, v115
    v_accvgpr_read_b32 v116, a24
    v_accvgpr_read_b32 v117, a25
    v_mfma_f32_16x16x32_bf16 a[28:31], a[228:231], v[140:143], a[28:31]
    v_accvgpr_read_b32 v118, a26
    v_accvgpr_read_b32 v119, a27
    ds_write_b64 v1, v[124:125]
    v_mul_f32 v116, v116, v192
    v_mul_f32 v117, v117, v192
    v_mul_f32 v118, v118, v192
    v_mfma_f32_16x16x32_bf16 a[28:31], v[222:225], v[164:167], a[28:31]
    v_mul_f32 v119, v119, v192
    v_cvt_pk_bf16_f32 v126, v116, v117
    v_cvt_pk_bf16_f32 v127, v118, v119
    v_accvgpr_read_b32 v120, a48
    v_accvgpr_read_b32 v121, a49
    v_accvgpr_read_b32 v122, a50
    v_accvgpr_read_b32 v123, a51
    v_mfma_f32_16x16x32_bf16 a[52:55], a[232:235], v[140:143], a[52:55]
    ds_write_b64 v2, v[126:127]
    v_mul_f32 v120, v120, v192
    v_mul_f32 v121, v121, v192
    v_mul_f32 v122, v122, v192
    v_mul_f32 v123, v123, v192
    v_cvt_pk_bf16_f32 v128, v120, v121
    v_mfma_f32_16x16x32_bf16 a[52:55], v[226:229], v[164:167], a[52:55]
    v_cvt_pk_bf16_f32 v129, v122, v123
    v_accvgpr_read_b32 v112, a72
    v_accvgpr_read_b32 v113, a73
    v_accvgpr_read_b32 v114, a74
    v_accvgpr_read_b32 v115, a75
    ds_write_b64 v3, v[128:129]
    v_mfma_f32_16x16x32_bf16 a[76:79], a[236:239], v[140:143], a[76:79]
    v_mul_f32 v112, v112, v192
    v_mul_f32 v113, v113, v192
    v_mul_f32 v114, v114, v192
    v_mul_f32 v115, v115, v192
    v_cvt_pk_bf16_f32 v130, v112, v113
    v_cvt_pk_bf16_f32 v131, v114, v115
    v_mfma_f32_16x16x32_bf16 a[76:79], v[230:233], v[164:167], a[76:79]
    v_mul_f32 v116, v16, v192
    v_mul_f32 v117, v17, v192
    ds_write_b64 v4, v[130:131]
    v_mul_f32 v118, v18, v192
    v_mul_f32 v119, v19, v192
    v_cvt_pk_bf16_f32 v124, v116, v117
    v_cvt_pk_bf16_f32 v125, v118, v119
    v_mfma_f32_16x16x32_bf16 v[20:23], a[240:243], v[140:143], v[20:23]
    v_mul_f32 v120, v40, v192
    v_mul_f32 v121, v41, v192
    ds_write_b64 v5, v[124:125]
    v_mul_f32 v122, v42, v192
    v_mul_f32 v123, v43, v192
    v_cvt_pk_bf16_f32 v126, v120, v121
    v_mfma_f32_16x16x32_bf16 v[20:23], v[234:237], v[164:167], v[20:23]
    v_cvt_pk_bf16_f32 v127, v122, v123
    v_mul_f32 v112, v64, v192
    v_mul_f32 v113, v65, v192
    ds_write_b64 v6, v[126:127]
    v_mul_f32 v114, v66, v192
    v_mul_f32 v115, v67, v192
    v_mfma_f32_16x16x32_bf16 v[44:47], a[244:247], v[140:143], v[44:47]
    v_cvt_pk_bf16_f32 v128, v112, v113
    v_cvt_pk_bf16_f32 v129, v114, v115
    v_mul_f32 v116, v88, v192
    v_mul_f32 v117, v89, v192
    ds_write_b64 v7, v[128:129]
    v_mul_f32 v118, v90, v192
    v_mfma_f32_16x16x32_bf16 v[44:47], v[238:241], v[164:167], v[44:47]
    v_mul_f32 v119, v91, v192
    v_cvt_pk_bf16_f32 v130, v116, v117
    v_cvt_pk_bf16_f32 v131, v118, v119
    ds_write_b64 v8, v[130:131]
    ds_read_b128 a[192:195], v9
    ds_read_b128 a[196:199], v10 offset:1024
    ds_read_b128 a[200:203], v11 offset:2048
    v_mfma_f32_16x16x32_bf16 v[68:71], a[248:251], v[140:143], v[68:71]
    ds_read_b128 a[204:207], v12 offset:3072
    v_mov_b32 v184, v193
    s_nop 1
    v_permlane32_swap_b32 v193, v184
    v_add_f32 v193, v193, v184
    v_mov_b32 v184, v193
    v_mfma_f32_16x16x32_bf16 v[68:71], v[242:245], v[164:167], v[68:71]
    s_nop 1
    v_permlane16_swap_b32 v193, v184
    v_add_f32 v193, v193, v184
    v_cmp_ngt_f32 vcc, s50, v193
    v_rcp_f32 v193, v193
    s_nop 0
    v_mfma_f32_16x16x32_bf16 v[92:95], a[252:255], v[140:143], v[92:95]
    s_or_b64 s[48:49], s[48:49], vcc
    s_waitcnt lgkmcnt(3)
    buffer_store_dwordx4 a[192:195], v13, s[28:31], 0 offen sc0 sc1
    v_mfma_f32_16x16x32_bf16 v[132:135], a[208:211], a[192:195], v[132:135]
    s_waitcnt lgkmcnt(2)
    buffer_store_dwordx4 a[196:199], v13, s[28:31], 0 offen offset:1024 sc0 sc1
    v_mfma_f32_16x16x32_bf16 v[92:95], v[246:249], v[164:167], v[92:95]
    v_mfma_f32_16x16x32_bf16 v[132:135], a[208:211], a[196:199], v[132:135]
    s_waitcnt lgkmcnt(1)
    buffer_store_dwordx4 a[200:203], v13, s[28:31], 0 offen offset:2048 sc0 sc1
    v_mfma_f32_16x16x32_bf16 v[132:135], a[208:211], a[200:203], v[132:135]
    s_waitcnt lgkmcnt(0)
    buffer_store_dwordx4 a[204:207], v13, s[28:31], 0 offen offset:3072 sc0 sc1
    v_mfma_f32_16x16x32_bf16 v[132:135], a[208:211], a[204:207], v[132:135]
    v_mfma_f32_16x16x32_bf16 a[8:11], a[224:227], v[144:147], a[8:11]
    v_accvgpr_read_b32 v112, a4
    v_accvgpr_read_b32 v113, a5
    v_accvgpr_read_b32 v114, a6
    v_accvgpr_read_b32 v115, a7
    v_mul_f32 v112, v112, v193
    v_mul_f32 v113, v113, v193
    v_mfma_f32_16x16x32_bf16 a[8:11], v[218:221], v[168:171], a[8:11]
    v_mul_f32 v114, v114, v193
    v_mul_f32 v115, v115, v193
    v_cvt_pk_bf16_f32 v124, v112, v113
    v_cvt_pk_bf16_f32 v125, v114, v115
    v_accvgpr_read_b32 v116, a28
    v_accvgpr_read_b32 v117, a29
    v_mfma_f32_16x16x32_bf16 a[32:35], a[228:231], v[144:147], a[32:35]
    v_accvgpr_read_b32 v118, a30
    v_accvgpr_read_b32 v119, a31
    ds_write_b64 v1, v[124:125]
    v_mul_f32 v116, v116, v193
    v_mul_f32 v117, v117, v193
    v_mul_f32 v118, v118, v193
    v_mfma_f32_16x16x32_bf16 a[32:35], v[222:225], v[168:171], a[32:35]
    v_mul_f32 v119, v119, v193
    v_cvt_pk_bf16_f32 v126, v116, v117
    v_cvt_pk_bf16_f32 v127, v118, v119
    v_accvgpr_read_b32 v120, a52
    v_accvgpr_read_b32 v121, a53
    v_accvgpr_read_b32 v122, a54
    v_accvgpr_read_b32 v123, a55
    v_mfma_f32_16x16x32_bf16 a[56:59], a[232:235], v[144:147], a[56:59]
    ds_write_b64 v2, v[126:127]
    v_mul_f32 v120, v120, v193
    v_mul_f32 v121, v121, v193
    v_mul_f32 v122, v122, v193
    v_mul_f32 v123, v123, v193
    v_cvt_pk_bf16_f32 v128, v120, v121
    v_mfma_f32_16x16x32_bf16 a[56:59], v[226:229], v[168:171], a[56:59]
    v_cvt_pk_bf16_f32 v129, v122, v123
    v_accvgpr_read_b32 v112, a76
    v_accvgpr_read_b32 v113, a77
    v_accvgpr_read_b32 v114, a78
    v_accvgpr_read_b32 v115, a79
    ds_write_b64 v3, v[128:129]
    v_mfma_f32_16x16x32_bf16 a[80:83], a[236:239], v[144:147], a[80:83]
    v_mul_f32 v112, v112, v193
    v_mul_f32 v113, v113, v193
    v_mul_f32 v114, v114, v193
    v_mul_f32 v115, v115, v193
    v_cvt_pk_bf16_f32 v130, v112, v113
    v_cvt_pk_bf16_f32 v131, v114, v115
    v_mfma_f32_16x16x32_bf16 a[80:83], v[230:233], v[168:171], a[80:83]
    v_mul_f32 v116, v20, v193
    v_mul_f32 v117, v21, v193
    ds_write_b64 v4, v[130:131]
    v_mul_f32 v118, v22, v193
    v_mul_f32 v119, v23, v193
    v_cvt_pk_bf16_f32 v124, v116, v117
    v_cvt_pk_bf16_f32 v125, v118, v119
    v_mfma_f32_16x16x32_bf16 v[24:27], a[240:243], v[144:147], v[24:27]
    v_mul_f32 v120, v44, v193
    v_mul_f32 v121, v45, v193
    ds_write_b64 v5, v[124:125]
    v_mul_f32 v122, v46, v193
    v_mul_f32 v123, v47, v193
    v_cvt_pk_bf16_f32 v126, v120, v121
    v_mfma_f32_16x16x32_bf16 v[24:27], v[234:237], v[168:171], v[24:27]
    v_cvt_pk_bf16_f32 v127, v122, v123
    v_mul_f32 v112, v68, v193
    v_mul_f32 v113, v69, v193
    ds_write_b64 v6, v[126:127]
    v_mul_f32 v114, v70, v193
    v_mul_f32 v115, v71, v193
    v_mfma_f32_16x16x32_bf16 v[48:51], a[244:247], v[144:147], v[48:51]
    v_cvt_pk_bf16_f32 v128, v112, v113
    v_cvt_pk_bf16_f32 v129, v114, v115
    v_mul_f32 v116, v92, v193
    v_mul_f32 v117, v93, v193
    ds_write_b64 v7, v[128:129]
    v_mul_f32 v118, v94, v193
    v_mfma_f32_16x16x32_bf16 v[48:51], v[238:241], v[168:171], v[48:51]
    v_mul_f32 v119, v95, v193
    v_cvt_pk_bf16_f32 v130, v116, v117
    v_cvt_pk_bf16_f32 v131, v118, v119
    ds_write_b64 v8, v[130:131]
    ds_read_b128 a[192:195], v9
    ds_read_b128 a[196:199], v10 offset:1024
    ds_read_b128 a[200:203], v11 offset:2048
    v_mfma_f32_16x16x32_bf16 v[72:75], a[248:251], v[144:147], v[72:75]
    ds_read_b128 a[204:207], v12 offset:3072
    v_mov_b32 v184, v194
    s_nop 1
    v_permlane32_swap_b32 v194, v184
    v_add_f32 v194, v194, v184
    v_mov_b32 v184, v194
    v_mfma_f32_16x16x32_bf16 v[72:75], v[242:245], v[168:171], v[72:75]
    s_nop 1
    v_permlane16_swap_b32 v194, v184
    v_add_f32 v194, v194, v184
    v_cmp_ngt_f32 vcc, s50, v194
    v_rcp_f32 v194, v194
    s_nop 0
    v_mfma_f32_16x16x32_bf16 v[96:99], a[252:255], v[144:147], v[96:99]
    s_or_b64 s[48:49], s[48:49], vcc
    s_waitcnt lgkmcnt(3)
    buffer_store_dwordx4 a[192:195], v13, s[28:31], s41 offen sc0 sc1
    v_mfma_f32_16x16x32_bf16 v[132:135], a[208:211], a[192:195], v[132:135]
    s_waitcnt lgkmcnt(2)
    buffer_store_dwordx4 a[196:199], v13, s[28:31], s41 offen offset:1024 sc0 sc1
    v_mfma_f32_16x16x32_bf16 v[96:99], v[246:249], v[168:171], v[96:99]
    v_mfma_f32_16x16x32_bf16 v[132:135], a[208:211], a[196:199], v[132:135]
    s_waitcnt lgkmcnt(1)
    buffer_store_dwordx4 a[200:203], v13, s[28:31], s41 offen offset:2048 sc0 sc1
    v_mfma_f32_16x16x32_bf16 v[132:135], a[208:211], a[200:203], v[132:135]
    s_waitcnt lgkmcnt(0)
    buffer_store_dwordx4 a[204:207], v13, s[28:31], s41 offen offset:3072 sc0 sc1
    v_mfma_f32_16x16x32_bf16 v[132:135], a[208:211], a[204:207], v[132:135]
    v_mfma_f32_16x16x32_bf16 a[12:15], a[224:227], v[148:151], a[12:15]
    v_accvgpr_read_b32 v112, a8
    v_accvgpr_read_b32 v113, a9
    v_accvgpr_read_b32 v114, a10
    v_accvgpr_read_b32 v115, a11
    v_mul_f32 v112, v112, v194
    v_mul_f32 v113, v113, v194
    v_mfma_f32_16x16x32_bf16 a[12:15], v[218:221], v[172:175], a[12:15]
    v_mul_f32 v114, v114, v194
    v_mul_f32 v115, v115, v194
    v_cvt_pk_bf16_f32 v124, v112, v113
    v_cvt_pk_bf16_f32 v125, v114, v115
    v_accvgpr_read_b32 v116, a32
    v_accvgpr_read_b32 v117, a33
    v_mfma_f32_16x16x32_bf16 a[36:39], a[228:231], v[148:151], a[36:39]
    v_accvgpr_read_b32 v118, a34
    v_accvgpr_read_b32 v119, a35
    ds_write_b64 v1, v[124:125]
    v_mul_f32 v116, v116, v194
    v_mul_f32 v117, v117, v194
    v_mul_f32 v118, v118, v194
    v_mfma_f32_16x16x32_bf16 a[36:39], v[222:225], v[172:175], a[36:39]
    v_mul_f32 v119, v119, v194
    v_cvt_pk_bf16_f32 v126, v116, v117
    v_cvt_pk_bf16_f32 v127, v118, v119
    v_accvgpr_read_b32 v120, a56
    v_accvgpr_read_b32 v121, a57
    v_accvgpr_read_b32 v122, a58
    v_accvgpr_read_b32 v123, a59
    v_mfma_f32_16x16x32_bf16 a[60:63], a[232:235], v[148:151], a[60:63]
    ds_write_b64 v2, v[126:127]
    v_mul_f32 v120, v120, v194
    v_mul_f32 v121, v121, v194
    v_mul_f32 v122, v122, v194
    v_mul_f32 v123, v123, v194
    v_cvt_pk_bf16_f32 v128, v120, v121
    v_mfma_f32_16x16x32_bf16 a[60:63], v[226:229], v[172:175], a[60:63]
    v_cvt_pk_bf16_f32 v129, v122, v123
    v_accvgpr_read_b32 v112, a80
    v_accvgpr_read_b32 v113, a81
    v_accvgpr_read_b32 v114, a82
    v_accvgpr_read_b32 v115, a83
    ds_write_b64 v3, v[128:129]
    v_mfma_f32_16x16x32_bf16 a[84:87], a[236:239], v[148:151], a[84:87]
    v_mul_f32 v112, v112, v194
    v_mul_f32 v113, v113, v194
    v_mul_f32 v114, v114, v194
    v_mul_f32 v115, v115, v194
    v_cvt_pk_bf16_f32 v130, v112, v113
    v_cvt_pk_bf16_f32 v131, v114, v115
    v_mfma_f32_16x16x32_bf16 a[84:87], v[230:233], v[172:175], a[84:87]
    v_mul_f32 v116, v24, v194
    v_mul_f32 v117, v25, v194
    ds_write_b64 v4, v[130:131]
    v_mul_f32 v118, v26, v194
    v_mul_f32 v119, v27, v194
    v_cvt_pk_bf16_f32 v124, v116, v117
    v_cvt_pk_bf16_f32 v125, v118, v119
    v_mfma_f32_16x16x32_bf16 v[28:31], a[240:243], v[148:151], v[28:31]
    v_mul_f32 v120, v48, v194
    v_mul_f32 v121, v49, v194
    ds_write_b64 v5, v[124:125]
    v_mul_f32 v122, v50, v194
    v_mul_f32 v123, v51, v194
    v_cvt_pk_bf16_f32 v126, v120, v121
    v_mfma_f32_16x16x32_bf16 v[28:31], v[234:237], v[172:175], v[28:31]
    v_cvt_pk_bf16_f32 v127, v122, v123
    v_mul_f32 v112, v72, v194
    v_mul_f32 v113, v73, v194
    ds_write_b64 v6, v[126:127]
    v_mul_f32 v114, v74, v194
    v_mul_f32 v115, v75, v194
    v_mfma_f32_16x16x32_bf16 v[52:55], a[244:247], v[148:151], v[52:55]
    v_cvt_pk_bf16_f32 v128, v112, v113
    v_cvt_pk_bf16_f32 v129, v114, v115
    v_mul_f32 v116, v96, v194
    v_mul_f32 v117, v97, v194
    ds_write_b64 v7, v[128:129]
    v_mul_f32 v118, v98, v194
    v_mfma_f32_16x16x32_bf16 v[52:55], v[238:241], v[172:175], v[52:55]
    v_mul_f32 v119, v99, v194
    v_cvt_pk_bf16_f32 v130, v116, v117
    v_cvt_pk_bf16_f32 v131, v118, v119
    ds_write_b64 v8, v[130:131]
    ds_read_b128 a[192:195], v9
    ds_read_b128 a[196:199], v10 offset:1024
    ds_read_b128 a[200:203], v11 offset:2048
    v_mfma_f32_16x16x32_bf16 v[76:79], a[248:251], v[148:151], v[76:79]
    ds_read_b128 a[204:207], v12 offset:3072
    v_mov_b32 v184, v195
    s_nop 1
    v_permlane32_swap_b32 v195, v184
    v_add_f32 v195, v195, v184
    v_mov_b32 v184, v195
    v_mfma_f32_16x16x32_bf16 v[76:79], v[242:245], v[172:175], v[76:79]
    s_nop 1
    v_permlane16_swap_b32 v195, v184
    v_add_f32 v195, v195, v184
    v_cmp_ngt_f32 vcc, s50, v195
    v_rcp_f32 v195, v195
    s_nop 0
    v_mfma_f32_16x16x32_bf16 v[100:103], a[252:255], v[148:151], v[100:103]
    s_or_b64 s[48:49], s[48:49], vcc
    s_waitcnt lgkmcnt(3)
    buffer_store_dwordx4 a[192:195], v13, s[28:31], s42 offen sc0 sc1
    v_mfma_f32_16x16x32_bf16 v[132:135], a[208:211], a[192:195], v[132:135]
    s_waitcnt lgkmcnt(2)
    buffer_store_dwordx4 a[196:199], v13, s[28:31], s42 offen offset:1024 sc0 sc1
    v_mfma_f32_16x16x32_bf16 v[100:103], v[246:249], v[172:175], v[100:103]
    v_mfma_f32_16x16x32_bf16 v[132:135], a[208:211], a[196:199], v[132:135]
    s_waitcnt lgkmcnt(1)
    buffer_store_dwordx4 a[200:203], v13, s[28:31], s42 offen offset:2048 sc0 sc1
    v_mfma_f32_16x16x32_bf16 v[132:135], a[208:211], a[200:203], v[132:135]
    s_waitcnt lgkmcnt(0)
    buffer_store_dwordx4 a[204:207], v13, s[28:31], s42 offen offset:3072 sc0 sc1
    v_mfma_f32_16x16x32_bf16 v[132:135], a[208:211], a[204:207], v[132:135]
    v_mfma_f32_16x16x32_bf16 a[16:19], a[224:227], v[152:155], a[16:19]
    v_accvgpr_read_b32 v112, a12
    v_accvgpr_read_b32 v113, a13
    v_accvgpr_read_b32 v114, a14
    v_accvgpr_read_b32 v115, a15
    v_mul_f32 v112, v112, v195
    v_mul_f32 v113, v113, v195
    v_mfma_f32_16x16x32_bf16 a[16:19], v[218:221], v[176:179], a[16:19]
    v_mul_f32 v114, v114, v195
    v_mul_f32 v115, v115, v195
    v_cvt_pk_bf16_f32 v124, v112, v113
    v_cvt_pk_bf16_f32 v125, v114, v115
    v_accvgpr_read_b32 v116, a36
    v_accvgpr_read_b32 v117, a37
    v_mfma_f32_16x16x32_bf16 a[40:43], a[228:231], v[152:155], a[40:43]
    v_accvgpr_read_b32 v118, a38
    v_accvgpr_read_b32 v119, a39
    ds_write_b64 v1, v[124:125]
    v_mul_f32 v116, v116, v195
    v_mul_f32 v117, v117, v195
    v_mul_f32 v118, v118, v195
    v_mfma_f32_16x16x32_bf16 a[40:43], v[222:225], v[176:179], a[40:43]
    v_mul_f32 v119, v119, v195
    v_cvt_pk_bf16_f32 v126, v116, v117
    v_cvt_pk_bf16_f32 v127, v118, v119
    v_accvgpr_read_b32 v120, a60
    v_accvgpr_read_b32 v121, a61
    v_accvgpr_read_b32 v122, a62
    v_accvgpr_read_b32 v123, a63
    v_mfma_f32_16x16x32_bf16 a[64:67], a[232:235], v[152:155], a[64:67]
    ds_write_b64 v2, v[126:127]
    v_mul_f32 v120, v120, v195
    v_mul_f32 v121, v121, v195
    v_mul_f32 v122, v122, v195
    v_mul_f32 v123, v123, v195
    v_cvt_pk_bf16_f32 v128, v120, v121
    v_mfma_f32_16x16x32_bf16 a[64:67], v[226:229], v[176:179], a[64:67]
    v_cvt_pk_bf16_f32 v129, v122, v123
    v_accvgpr_read_b32 v112, a84
    v_accvgpr_read_b32 v113, a85
    v_accvgpr_read_b32 v114, a86
    v_accvgpr_read_b32 v115, a87
    ds_write_b64 v3, v[128:129]
    v_mfma_f32_16x16x32_bf16 a[88:91], a[236:239], v[152:155], a[88:91]
    v_mul_f32 v112, v112, v195
    v_mul_f32 v113, v113, v195
    v_mul_f32 v114, v114, v195
    v_mul_f32 v115, v115, v195
    v_cvt_pk_bf16_f32 v130, v112, v113
    v_cvt_pk_bf16_f32 v131, v114, v115
    v_mfma_f32_16x16x32_bf16 a[88:91], v[230:233], v[176:179], a[88:91]
    v_mul_f32 v116, v28, v195
    v_mul_f32 v117, v29, v195
    ds_write_b64 v4, v[130:131]
    v_mul_f32 v118, v30, v195
    v_mul_f32 v119, v31, v195
    v_cvt_pk_bf16_f32 v124, v116, v117
    v_cvt_pk_bf16_f32 v125, v118, v119
    v_mfma_f32_16x16x32_bf16 v[32:35], a[240:243], v[152:155], v[32:35]
    v_mul_f32 v120, v52, v195
    v_mul_f32 v121, v53, v195
    ds_write_b64 v5, v[124:125]
    v_mul_f32 v122, v54, v195
    v_mul_f32 v123, v55, v195
    v_cvt_pk_bf16_f32 v126, v120, v121
    v_mfma_f32_16x16x32_bf16 v[32:35], v[234:237], v[176:179], v[32:35]
    v_cvt_pk_bf16_f32 v127, v122, v123
    v_mul_f32 v112, v76, v195
    v_mul_f32 v113, v77, v195
    ds_write_b64 v6, v[126:127]
    v_mul_f32 v114, v78, v195
    v_mul_f32 v115, v79, v195
    v_mfma_f32_16x16x32_bf16 v[56:59], a[244:247], v[152:155], v[56:59]
    v_cvt_pk_bf16_f32 v128, v112, v113
    v_cvt_pk_bf16_f32 v129, v114, v115
    v_mul_f32 v116, v100, v195
    v_mul_f32 v117, v101, v195
    ds_write_b64 v7, v[128:129]
    v_mul_f32 v118, v102, v195
    v_mfma_f32_16x16x32_bf16 v[56:59], v[238:241], v[176:179], v[56:59]
    v_mul_f32 v119, v103, v195
    v_cvt_pk_bf16_f32 v130, v116, v117
    v_cvt_pk_bf16_f32 v131, v118, v119
    ds_write_b64 v8, v[130:131]
    ds_read_b128 a[192:195], v9
    ds_read_b128 a[196:199], v10 offset:1024
    ds_read_b128 a[200:203], v11 offset:2048
    v_mfma_f32_16x16x32_bf16 v[80:83], a[248:251], v[152:155], v[80:83]
    ds_read_b128 a[204:207], v12 offset:3072
    v_mov_b32 v184, v196
    s_nop 1
    v_permlane32_swap_b32 v196, v184
    v_add_f32 v196, v196, v184
    v_mov_b32 v184, v196
    v_mfma_f32_16x16x32_bf16 v[80:83], v[242:245], v[176:179], v[80:83]
    s_nop 1
    v_permlane16_swap_b32 v196, v184
    v_add_f32 v196, v196, v184
    v_cmp_ngt_f32 vcc, s50, v196
    v_rcp_f32 v196, v196
    s_nop 0
    v_mfma_f32_16x16x32_bf16 v[104:107], a[252:255], v[152:155], v[104:107]
    s_or_b64 s[48:49], s[48:49], vcc
    s_waitcnt lgkmcnt(3)
    buffer_store_dwordx4 a[192:195], v13, s[28:31], s43 offen sc0 sc1
    v_mfma_f32_16x16x32_bf16 v[132:135], a[208:211], a[192:195], v[132:135]
    s_waitcnt lgkmcnt(2)
    buffer_store_dwordx4 a[196:199], v13, s[28:31], s43 offen offset:1024 sc0 sc1
    v_mfma_f32_16x16x32_bf16 v[104:107], v[246:249], v[176:179], v[104:107]
    v_mfma_f32_16x16x32_bf16 v[132:135], a[208:211], a[196:199], v[132:135]
    s_waitcnt lgkmcnt(1)
    buffer_store_dwordx4 a[200:203], v13, s[28:31], s43 offen offset:2048 sc0 sc1
    v_mfma_f32_16x16x32_bf16 v[132:135], a[208:211], a[200:203], v[132:135]
    s_waitcnt lgkmcnt(0)
    buffer_store_dwordx4 a[204:207], v13, s[28:31], s43 offen offset:3072 sc0 sc1
    v_mfma_f32_16x16x32_bf16 v[132:135], a[208:211], a[204:207], v[132:135]
    v_mfma_f32_16x16x32_bf16 a[20:23], a[224:227], v[156:159], a[20:23]
    v_accvgpr_read_b32 v112, a16
    v_accvgpr_read_b32 v113, a17
    v_accvgpr_read_b32 v114, a18
    v_accvgpr_read_b32 v115, a19
    v_mul_f32 v112, v112, v196
    v_mul_f32 v113, v113, v196
    v_mfma_f32_16x16x32_bf16 a[20:23], v[218:221], v[180:183], a[20:23]
    v_mul_f32 v114, v114, v196
    v_mul_f32 v115, v115, v196
    v_cvt_pk_bf16_f32 v124, v112, v113
    v_cvt_pk_bf16_f32 v125, v114, v115
    v_accvgpr_read_b32 v116, a40
    v_accvgpr_read_b32 v117, a41
    v_mfma_f32_16x16x32_bf16 a[44:47], a[228:231], v[156:159], a[44:47]
    v_accvgpr_read_b32 v118, a42
    v_accvgpr_read_b32 v119, a43
    ds_write_b64 v1, v[124:125]
    v_mul_f32 v116, v116, v196
    v_mul_f32 v117, v117, v196
    v_mul_f32 v118, v118, v196
    v_mfma_f32_16x16x32_bf16 a[44:47], v[222:225], v[180:183], a[44:47]
    v_mul_f32 v119, v119, v196
    v_cvt_pk_bf16_f32 v126, v116, v117
    v_cvt_pk_bf16_f32 v127, v118, v119
    v_accvgpr_read_b32 v120, a64
    v_accvgpr_read_b32 v121, a65
    v_accvgpr_read_b32 v122, a66
    v_accvgpr_read_b32 v123, a67
    v_mfma_f32_16x16x32_bf16 a[68:71], a[232:235], v[156:159], a[68:71]
    ds_write_b64 v2, v[126:127]
    v_mul_f32 v120, v120, v196
    v_mul_f32 v121, v121, v196
    v_mul_f32 v122, v122, v196
    v_mul_f32 v123, v123, v196
    v_cvt_pk_bf16_f32 v128, v120, v121
    v_mfma_f32_16x16x32_bf16 a[68:71], v[226:229], v[180:183], a[68:71]
    v_cvt_pk_bf16_f32 v129, v122, v123
    v_accvgpr_read_b32 v112, a88
    v_accvgpr_read_b32 v113, a89
    v_accvgpr_read_b32 v114, a90
    v_accvgpr_read_b32 v115, a91
    ds_write_b64 v3, v[128:129]
    v_mfma_f32_16x16x32_bf16 a[92:95], a[236:239], v[156:159], a[92:95]
    v_mul_f32 v112, v112, v196
    v_mul_f32 v113, v113, v196
    v_mul_f32 v114, v114, v196
    v_mul_f32 v115, v115, v196
    v_cvt_pk_bf16_f32 v130, v112, v113
    v_cvt_pk_bf16_f32 v131, v114, v115
    v_mfma_f32_16x16x32_bf16 a[92:95], v[230:233], v[180:183], a[92:95]
    v_mul_f32 v116, v32, v196
    v_mul_f32 v117, v33, v196
    ds_write_b64 v4, v[130:131]
    v_mul_f32 v118, v34, v196
    v_mul_f32 v119, v35, v196
    v_cvt_pk_bf16_f32 v124, v116, v117
    v_cvt_pk_bf16_f32 v125, v118, v119
    v_mfma_f32_16x16x32_bf16 v[36:39], a[240:243], v[156:159], v[36:39]
    v_mul_f32 v120, v56, v196
    v_mul_f32 v121, v57, v196
    ds_write_b64 v5, v[124:125]
    v_mul_f32 v122, v58, v196
    v_mul_f32 v123, v59, v196
    v_cvt_pk_bf16_f32 v126, v120, v121
    v_mfma_f32_16x16x32_bf16 v[36:39], v[234:237], v[180:183], v[36:39]
    v_cvt_pk_bf16_f32 v127, v122, v123
    v_mul_f32 v112, v80, v196
    v_mul_f32 v113, v81, v196
    ds_write_b64 v6, v[126:127]
    v_mul_f32 v114, v82, v196
    v_mul_f32 v115, v83, v196
    v_mfma_f32_16x16x32_bf16 v[60:63], a[244:247], v[156:159], v[60:63]
    v_cvt_pk_bf16_f32 v128, v112, v113
    v_cvt_pk_bf16_f32 v129, v114, v115
    v_mul_f32 v116, v104, v196
    v_mul_f32 v117, v105, v196
    ds_write_b64 v7, v[128:129]
    v_mul_f32 v118, v106, v196
    v_mfma_f32_16x16x32_bf16 v[60:63], v[238:241], v[180:183], v[60:63]
    v_mul_f32 v119, v107, v196
    v_cvt_pk_bf16_f32 v130, v116, v117
    v_cvt_pk_bf16_f32 v131, v118, v119
    ds_write_b64 v8, v[130:131]
    ds_read_b128 a[192:195], v9
    ds_read_b128 a[196:199], v10 offset:1024
    ds_read_b128 a[200:203], v11 offset:2048
    v_mfma_f32_16x16x32_bf16 v[84:87], a[248:251], v[156:159], v[84:87]
    ds_read_b128 a[204:207], v12 offset:3072
    v_mov_b32 v184, v197
    s_nop 1
    v_permlane32_swap_b32 v197, v184
    v_add_f32 v197, v197, v184
    v_mov_b32 v184, v197
    v_mfma_f32_16x16x32_bf16 v[84:87], v[242:245], v[180:183], v[84:87]
    s_nop 1
    v_permlane16_swap_b32 v197, v184
    v_add_f32 v197, v197, v184
    v_cmp_ngt_f32 vcc, s50, v197
    v_rcp_f32 v197, v197
    s_nop 0
    v_mfma_f32_16x16x32_bf16 v[108:111], a[252:255], v[156:159], v[108:111]
    s_or_b64 s[48:49], s[48:49], vcc
    s_waitcnt lgkmcnt(3)
    buffer_store_dwordx4 a[192:195], v13, s[28:31], s44 offen sc0 sc1
    v_mfma_f32_16x16x32_bf16 v[132:135], a[208:211], a[192:195], v[132:135]
    s_waitcnt lgkmcnt(2)
    buffer_store_dwordx4 a[196:199], v13, s[28:31], s44 offen offset:1024 sc0 sc1
    v_mfma_f32_16x16x32_bf16 v[108:111], v[246:249], v[180:183], v[108:111]
    v_mfma_f32_16x16x32_bf16 v[132:135], a[208:211], a[196:199], v[132:135]
    s_waitcnt lgkmcnt(1)
    buffer_store_dwordx4 a[200:203], v13, s[28:31], s44 offen offset:2048 sc0 sc1
    v_mfma_f32_16x16x32_bf16 v[132:135], a[208:211], a[200:203], v[132:135]
    s_waitcnt lgkmcnt(0)
    buffer_store_dwordx4 a[204:207], v13, s[28:31], s44 offen offset:3072 sc0 sc1
    v_mfma_f32_16x16x32_bf16 v[132:135], a[208:211], a[204:207], v[132:135]
    s_nop 7
    v_accvgpr_read_b32 v112, a20
    v_accvgpr_read_b32 v113, a21
    v_accvgpr_read_b32 v114, a22
    v_accvgpr_read_b32 v115, a23
    v_mul_f32 v112, v112, v197
    v_mul_f32 v113, v113, v197
    v_mul_f32 v114, v114, v197
    v_mul_f32 v115, v115, v197
    v_cvt_pk_bf16_f32 v124, v112, v113
    v_cvt_pk_bf16_f32 v125, v114, v115
    v_accvgpr_read_b32 v116, a44
    v_accvgpr_read_b32 v117, a45
    v_accvgpr_read_b32 v118, a46
    v_accvgpr_read_b32 v119, a47
    ds_write_b64 v1, v[124:125]
    v_mul_f32 v116, v116, v197
    v_mul_f32 v117, v117, v197
    v_mul_f32 v118, v118, v197
    v_mul_f32 v119, v119, v197
    v_cvt_pk_bf16_f32 v126, v116, v117
    v_cvt_pk_bf16_f32 v127, v118, v119
    v_accvgpr_read_b32 v120, a68
    v_accvgpr_read_b32 v121, a69
    v_accvgpr_read_b32 v122, a70
    v_accvgpr_read_b32 v123, a71
    ds_write_b64 v2, v[126:127]
    v_mul_f32 v120, v120, v197
    v_mul_f32 v121, v121, v197
    v_mul_f32 v122, v122, v197
    v_mul_f32 v123, v123, v197
    v_cvt_pk_bf16_f32 v128, v120, v121
    v_cvt_pk_bf16_f32 v129, v122, v123
    v_accvgpr_read_b32 v112, a92
    v_accvgpr_read_b32 v113, a93
    v_accvgpr_read_b32 v114, a94
    v_accvgpr_read_b32 v115, a95
    ds_write_b64 v3, v[128:129]
    v_mul_f32 v112, v112, v197
    v_mul_f32 v113, v113, v197
    v_mul_f32 v114, v114, v197
    v_mul_f32 v115, v115, v197
    v_cvt_pk_bf16_f32 v130, v112, v113
    v_cvt_pk_bf16_f32 v131, v114, v115
    v_mul_f32 v116, v36, v197
    v_mul_f32 v117, v37, v197
    ds_write_b64 v4, v[130:131]
    v_mul_f32 v118, v38, v197
    v_mul_f32 v119, v39, v197
    v_cvt_pk_bf16_f32 v124, v116, v117
    v_cvt_pk_bf16_f32 v125, v118, v119
    v_mul_f32 v120, v60, v197
    v_mul_f32 v121, v61, v197
    ds_write_b64 v5, v[124:125]
    v_mul_f32 v122, v62, v197
    v_mul_f32 v123, v63, v197
    v_cvt_pk_bf16_f32 v126, v120, v121
    v_cvt_pk_bf16_f32 v127, v122, v123
    v_mul_f32 v112, v84, v197
    v_mul_f32 v113, v85, v197
    ds_write_b64 v6, v[126:127]
    v_mul_f32 v114, v86, v197
    v_mul_f32 v115, v87, v197
    v_cvt_pk_bf16_f32 v128, v112, v113
    v_cvt_pk_bf16_f32 v129, v114, v115
    v_mul_f32 v116, v108, v197
    v_mul_f32 v117, v109, v197
    ds_write_b64 v7, v[128:129]
    v_mul_f32 v118, v110, v197
    v_mul_f32 v119, v111, v197
    v_cvt_pk_bf16_f32 v130, v116, v117
    v_cvt_pk_bf16_f32 v131, v118, v119
    ds_write_b64 v8, v[130:131]
    ds_read_b128 a[192:195], v9
    ds_read_b128 a[196:199], v10 offset:1024
    ds_read_b128 a[200:203], v11 offset:2048
    ds_read_b128 a[204:207], v12 offset:3072
    s_waitcnt lgkmcnt(3)
    buffer_store_dwordx4 a[192:195], v13, s[28:31], s45 offen sc0 sc1
    v_mfma_f32_16x16x32_bf16 v[132:135], a[208:211], a[192:195], v[132:135]
    s_waitcnt lgkmcnt(2)
    buffer_store_dwordx4 a[196:199], v13, s[28:31], s45 offen offset:1024 sc0 sc1
    v_mfma_f32_16x16x32_bf16 v[132:135], a[208:211], a[196:199], v[132:135]
    s_waitcnt lgkmcnt(1)
    buffer_store_dwordx4 a[200:203], v13, s[28:31], s45 offen offset:2048 sc0 sc1
    v_mfma_f32_16x16x32_bf16 v[132:135], a[208:211], a[200:203], v[132:135]
    s_waitcnt lgkmcnt(0)
    buffer_store_dwordx4 a[204:207], v13, s[28:31], s45 offen offset:3072 sc0 sc1
    v_mfma_f32_16x16x32_bf16 v[132:135], a[208:211], a[204:207], v[132:135]
    s_cmp_eq_u32 s37, 1
    s_cbranch_scc1 L_fin
    s_nop 7
    v_cmp_u_f32 vcc, v132, v132
    s_nop 1
    s_or_b64 s[48:49], s[48:49], vcc
    s_cmp_lg_u64 s[48:49], 0
    s_cselect_b32 s46, 1, 0
    v_mov_b32 v218, s46
    s_lshl_b32 s47, s32, 2
    s_add_u32 s47, s47, 163584
    v_mov_b32 v219, s47
    ds_write_b32 v219, v218
    s_waitcnt lgkmcnt(0)
    s_barrier
    v_mov_b32 v219, 163584
    ds_read_b128 v[222:225], v219
    s_waitcnt lgkmcnt(0)
    v_or_b32 v222, v222, v223
    v_or3_b32 v222, v222, v224, v225
    s_nop 0
    v_readfirstlane_b32 s46, v222
    s_nop 3
    s_cmp_lg_u32 s46, 0
    s_cbranch_scc1 L_safe
L_fin:
L_end:
    s_endpgm
L_pro_b:
    s_getpc_b64 s[72:73]
L_pc_b:
    s_sub_u32 s72, s72, L_pc_b-L_main_entry
    s_subb_u32 s73, s73, 0
    v_lshlrev_b32 v6, 7, v1
    s_lshl_b32 s74, s32, 13
    v_add_u32 v6, s74, v6
    s_mov_b32 s75, L_code_end-L_main_entry-4
    v_min_u32 v6, s75, v6
    global_load_dword v9, v6, s[72:73]
    s_add_u32 s28, s10, s33
    s_addc_u32 s29, s11, 0
    s_and_b32 s29, s29, 0xffff
    s_mov_b32 s30, 24576
    s_mov_b32 s31, 0x20000
    s_add_u32 s20, s16, 12288
    s_addc_u32 s21, s17, 0
    s_and_b32 s21, s21, 0xffff
    s_mov_b32 s22, 512000
    s_mov_b32 s23, 0x20000
    s_add_u32 s24, s8, s46
    s_addc_u32 s25, s9, 0
    s_and_b32 s25, s25, 0xffff
    s_mov_b32 s26, 524288
    s_mov_b32 s27, 0x20000
    s_add_u32 s88, s34, 0
    s_add_u32 s92, s35, 0
    s_add_u32 s89, s34, 16384
    s_add_u32 s93, s35, 16384
    s_add_u32 s90, s34, 32768
    s_add_u32 s94, s35, 32768
    s_add_u32 s91, s34, 49152
    s_add_u32 s95, s35, 49152
    s_mov_b32 s37, 0
    s_mov_b32 s38, 0x3e0293ee
    s_mov_b32 s50, 0x7b800000
    v_or_b32 v6, 0, v4
    v_lshlrev_b32 v6, 1, v6
    v_xor_b32 v6, v6, v3
    v_lshl_add_u32 v214, v6, 4, v8
    v_or_b32 v6, 4, v4
    v_lshlrev_b32 v6, 1, v6
    v_xor_b32 v6, v6, v3
    v_lshl_add_u32 v215, v6, 4, v8
    v_and_b32 v6, 1, v4
    v_lshl_add_u32 v6, v6, 5, v5
    v_lshrrev_b32 v7, 1, v4
    v_lshl_add_u32 v217, v7, 4, v6
    v_or_b32 v6, 0, v4
    v_xor_b32 v6, v6, v3
    v_lshl_add_u32 v198, v6, 4, v5
    v_or_b32 v6, 4, v4
    v_xor_b32 v6, v6, v3
    v_lshl_add_u32 v199, v6, 4, v5
    v_or_b32 v6, 8, v4
    v_xor_b32 v6, v6, v3
    v_lshl_add_u32 v200, v6, 4, v5
    v_or_b32 v6, 12, v4
    v_xor_b32 v6, v6, v3
    v_lshl_add_u32 v201, v6, 4, v5
    v_add_u32 v10, s78, v198
    v_add_u32 v11, s78, v199
    v_add_u32 v12, s78, v200
    v_add_u32 v13, s78, v201
    v_lshrrev_b32 v6, 2, v3
    v_lshl_add_u32 v6, v4, 2, v6
    v_and_b32 v7, 7, v6
    v_lshlrev_b32 v6, 8, v6
    v_and_b32 v8, 3, v3
    v_lshl_add_u32 v6, v8, 3, v6
    v_add_u32 v6, 65536, v6
    v_xor_b32 v8, 0, v7
    v_lshl_add_u32 v202, v8, 5, v6
    v_xor_b32 v8, 1, v7
    v_lshl_add_u32 v203, v8, 5, v6
    v_xor_b32 v8, 2, v7
    v_lshl_add_u32 v204, v8, 5, v6
    v_xor_b32 v8, 3, v7
    v_lshl_add_u32 v205, v8, 5, v6
    v_xor_b32 v8, 4, v7
    v_lshl_add_u32 v206, v8, 5, v6
    v_xor_b32 v8, 5, v7
    v_lshl_add_u32 v207, v8, 5, v6
    v_xor_b32 v8, 6, v7
    v_lshl_add_u32 v208, v8, 5, v6
    v_xor_b32 v8, 7, v7
    v_lshl_add_u32 v209, v8, 5, v6
    v_mov_b32 v192, 0
    v_mov_b32 v193, 0
    v_mov_b32 v194, 0
    v_mov_b32 v195, 0
    v_mov_b32 v196, 0
    v_mov_b32 v197, 0
    s_add_u32 s46, s34, 32768
    v_and_b32 v226, 63, v0
    v_and_b32 v227, 15, v226
    v_lshrrev_b32 v228, 4, v226
    v_and_b32 v229, 1, v228
    v_lshlrev_b32 v229, 3, v229
    v_lshl_add_u32 v229, v227, 8, v229
    v_add_u32 v229, s46, v229
    v_lshrrev_b32 v228, 1, v228
    v_or_b32 v230, 0, v228
    v_xor_b32 v230, v230, v227
    v_lshl_add_u32 v1, v230, 4, v229
    v_or_b32 v230, 2, v228
    v_xor_b32 v230, v230, v227
    v_lshl_add_u32 v2, v230, 4, v229
    v_or_b32 v230, 4, v228
    v_xor_b32 v230, v230, v227
    v_lshl_add_u32 v3, v230, 4, v229
    v_or_b32 v230, 6, v228
    v_xor_b32 v230, v230, v227
    v_lshl_add_u32 v4, v230, 4, v229
    v_or_b32 v230, 8, v228
    v_xor_b32 v230, v230, v227
    v_lshl_add_u32 v5, v230, 4, v229
    v_or_b32 v230, 10, v228
    v_xor_b32 v230, v230, v227
    v_lshl_add_u32 v6, v230, 4, v229
    v_or_b32 v230, 12, v228
    v_xor_b32 v230, v230, v227
    v_lshl_add_u32 v7, v230, 4, v229
    v_or_b32 v230, 14, v228
    v_xor_b32 v230, v230, v227
    v_lshl_add_u32 v8, v230, 4, v229
    s_waitcnt vmcnt(5)
    s_barrier
    ds_read_b128 a[240:243], v198 offset:53248
    ds_read_b128 a[244:247], v199 offset:53248
    ds_read_b128 a[248:251], v200 offset:53248
    ds_read_b128 a[252:255], v201 offset:53248
    ds_read_b128 a[208:211], v198 offset:57344
    ds_read_b128 a[212:215], v199 offset:57344
    ds_read_b128 a[216:219], v200 offset:57344
    ds_read_b128 a[220:223], v201 offset:57344
    ds_read_b128 a[192:195], v198 offset:61440
    ds_read_b128 a[196:199], v199 offset:61440
    ds_read_b128 a[200:203], v200 offset:61440
    ds_read_b128 a[204:207], v201 offset:61440
    s_waitcnt vmcnt(1)
    ds_read_b128 v[160:163], v10
    ds_read_b128 v[164:167], v11
    ds_read_b128 v[168:171], v12
    ds_read_b128 v[172:175], v13
    s_add_u32 m0, s78, 4096
    s_nop 0
    buffer_load_dwordx4 v210, s[12:15], s41 offen nt lds
    buffer_load_dwordx4 v211, s[12:15], s41 offen offset:1024 nt lds
    buffer_load_dwordx4 v212, s[12:15], s41 offen offset:2048 nt lds
    buffer_load_dwordx4 v213, s[12:15], s41 offen offset:3072 nt lds
    s_waitcnt lgkmcnt(0)
    v_lshlrev_b32 v218, 16, v160
    v_and_b32 v219, 0xffff0000, v160
    v_lshlrev_b32 v220, 16, v161
    v_and_b32 v221, 0xffff0000, v161
    v_mul_f32 v218, s38, v218
    v_mul_f32 v219, s38, v219
    v_mul_f32 v220, s38, v220
    v_mul_f32 v221, s38, v221
    v_cvt_pk_bf16_f32 v218, v218, v219
    v_cvt_pk_bf16_f32 v220, v220, v221
    v_accvgpr_write_b32 a96, v218
    v_accvgpr_write_b32 a97, v220
    v_lshlrev_b32 v218, 16, v162
    v_and_b32 v219, 0xffff0000, v162
    v_lshlrev_b32 v220, 16, v163
    v_and_b32 v221, 0xffff0000, v163
    v_mul_f32 v218, s38, v218
    v_mul_f32 v219, s38, v219
    v_mul_f32 v220, s38, v220
    v_mul_f32 v221, s38, v221
    v_cvt_pk_bf16_f32 v218, v218, v219
    v_cvt_pk_bf16_f32 v220, v220, v221
    v_accvgpr_write_b32 a98, v218
    v_accvgpr_write_b32 a99, v220
    v_lshlrev_b32 v218, 16, v164
    v_and_b32 v219, 0xffff0000, v164
    v_lshlrev_b32 v220, 16, v165
    v_and_b32 v221, 0xffff0000, v165
    v_mul_f32 v218, s38, v218
    v_mul_f32 v219, s38, v219
    v_mul_f32 v220, s38, v220
    v_mul_f32 v221, s38, v221
    v_cvt_pk_bf16_f32 v218, v218, v219
    v_cvt_pk_bf16_f32 v220, v220, v221
    v_accvgpr_write_b32 a100, v218
    v_accvgpr_write_b32 a101, v220
    v_lshlrev_b32 v218, 16, v166
    v_and_b32 v219, 0xffff0000, v166
    v_lshlrev_b32 v220, 16, v167
    v_and_b32 v221, 0xffff0000, v167
    v_mul_f32 v218, s38, v218
    v_mul_f32 v219, s38, v219
    v_mul_f32 v220, s38, v220
    v_mul_f32 v221, s38, v221
    v_cvt_pk_bf16_f32 v218, v218, v219
    v_cvt_pk_bf16_f32 v220, v220, v221
    v_accvgpr_write_b32 a102, v218
    v_accvgpr_write_b32 a103, v220
    v_lshlrev_b32 v218, 16, v168
    v_and_b32 v219, 0xffff0000, v168
    v_lshlrev_b32 v220, 16, v169
    v_and_b32 v221, 0xffff0000, v169
    v_mul_f32 v218, s38, v218
    v_mul_f32 v219, s38, v219
    v_mul_f32 v220, s38, v220
    v_mul_f32 v221, s38, v221
    v_cvt_pk_bf16_f32 v218, v218, v219
    v_cvt_pk_bf16_f32 v220, v220, v221
    v_accvgpr_write_b32 a104, v218
    v_accvgpr_write_b32 a105, v220
    v_lshlrev_b32 v218, 16, v170
    v_and_b32 v219, 0xffff0000, v170
    v_lshlrev_b32 v220, 16, v171
    v_and_b32 v221, 0xffff0000, v171
    v_mul_f32 v218, s38, v218
    v_mul_f32 v219, s38, v219
    v_mul_f32 v220, s38, v220
    v_mul_f32 v221, s38, v221
    v_cvt_pk_bf16_f32 v218, v218, v219
    v_cvt_pk_bf16_f32 v220, v220, v221
    v_accvgpr_write_b32 a106, v218
    v_accvgpr_write_b32 a107, v220
    v_lshlrev_b32 v218, 16, v172
    v_and_b32 v219, 0xffff0000, v172
    v_lshlrev_b32 v220, 16, v173
    v_and_b32 v221, 0xffff0000, v173
    v_mul_f32 v218, s38, v218
    v_mul_f32 v219, s38, v219
    v_mul_f32 v220, s38, v220
    v_mul_f32 v221, s38, v221
    v_cvt_pk_bf16_f32 v218, v218, v219
    v_cvt_pk_bf16_f32 v220, v220, v221
    v_accvgpr_write_b32 a108, v218
    v_accvgpr_write_b32 a109, v220
    v_lshlrev_b32 v218, 16, v174
    v_and_b32 v219, 0xffff0000, v174
    v_lshlrev_b32 v220, 16, v175
    v_and_b32 v221, 0xffff0000, v175
    v_mul_f32 v218, s38, v218
    v_mul_f32 v219, s38, v219
    v_mul_f32 v220, s38, v220
    v_mul_f32 v221, s38, v221
    v_cvt_pk_bf16_f32 v218, v218, v219
    v_cvt_pk_bf16_f32 v220, v220, v221
    v_accvgpr_write_b32 a110, v218
    v_accvgpr_write_b32 a111, v220
    s_waitcnt lgkmcnt(0)
    v_mfma_f32_16x16x32_bf16 v[184:187], a[240:243], a[96:99], 0
    v_mfma_f32_16x16x32_bf16 v[184:187], a[244:247], a[100:103], v[184:187]
    v_mfma_f32_16x16x32_bf16 v[184:187], a[248:251], a[104:107], v[184:187]
    v_mfma_f32_16x16x32_bf16 v[184:187], a[252:255], a[108:111], v[184:187]
    s_nop 7
    v_max3_f32 v222, v184, v185, v186
    v_max_f32 v222, v222, v187
    v_mov_b32 v223, v222
    s_nop 1
    v_permlane32_swap_b32 v222, v223
    v_max_f32 v222, v222, v223
    v_mov_b32 v223, v222
    s_nop 1
    v_permlane16_swap_b32 v222, v223
    v_max_f32 v222, v222, v223
    v_sub_f32 v112, 0, v222
    v_sub_f32 v113, 0, v222
    v_sub_f32 v114, 0, v222
    v_sub_f32 v115, 0, v222
    v_add_f32 v184, v184, v112
    v_add_f32 v185, v185, v112
    v_add_f32 v186, v186, v112
    v_add_f32 v187, v187, v112
    v_mfma_f32_16x16x32_bf16 v[188:191], a[208:211], a[96:99], v[112:115]
    v_mfma_f32_16x16x32_bf16 v[188:191], a[212:215], a[100:103], v[188:191]
    v_mfma_f32_16x16x32_bf16 v[188:191], a[216:219], a[104:107], v[188:191]
    v_mfma_f32_16x16x32_bf16 v[188:191], a[220:223], a[108:111], v[188:191]
    v_exp_f32 v184, v184
    v_exp_f32 v185, v185
    v_exp_f32 v186, v186
    v_exp_f32 v187, v187
    v_add_f32 v192, v192, v184
    v_add_f32 v192, v192, v185
    v_add_f32 v192, v192, v186
    v_add_f32 v192, v192, v187
    v_cvt_pk_bf16_f32 v136, v184, v185
    v_cvt_pk_bf16_f32 v137, v186, v187
    v_exp_f32 v188, v188
    v_exp_f32 v189, v189
    v_exp_f32 v190, v190
    v_exp_f32 v191, v191
    v_add_f32 v192, v192, v188
    v_add_f32 v192, v192, v189
    v_add_f32 v192, v192, v190
    v_add_f32 v192, v192, v191
    v_cvt_pk_bf16_f32 v138, v188, v189
    v_cvt_pk_bf16_f32 v139, v190, v191
    s_waitcnt vmcnt(0)
    ds_read_b128 v[160:163], v10 offset:4096
    ds_read_b128 v[164:167], v11 offset:4096
    ds_read_b128 v[168:171], v12 offset:4096
    ds_read_b128 v[172:175], v13 offset:4096
    s_add_u32 m0, s78, 8192
    s_nop 0
    buffer_load_dwordx4 v210, s[12:15], s42 offen nt lds
    buffer_load_dwordx4 v211, s[12:15], s42 offen offset:1024 nt lds
    buffer_load_dwordx4 v212, s[12:15], s42 offen offset:2048 nt lds
    buffer_load_dwordx4 v213, s[12:15], s42 offen offset:3072 nt lds
    s_waitcnt lgkmcnt(0)
    v_lshlrev_b32 v218, 16, v160
    v_and_b32 v219, 0xffff0000, v160
    v_lshlrev_b32 v220, 16, v161
    v_and_b32 v221, 0xffff0000, v161
    v_mul_f32 v218, s38, v218
    v_mul_f32 v219, s38, v219
    v_mul_f32 v220, s38, v220
    v_mul_f32 v221, s38, v221
    v_cvt_pk_bf16_f32 v218, v218, v219
    v_cvt_pk_bf16_f32 v220, v220, v221
    v_accvgpr_write_b32 a112, v218
    v_accvgpr_write_b32 a113, v220
    v_lshlrev_b32 v218, 16, v162
    v_and_b32 v219, 0xffff0000, v162
    v_lshlrev_b32 v220, 16, v163
    v_and_b32 v221, 0xffff0000, v163
    v_mul_f32 v218, s38, v218
    v_mul_f32 v219, s38, v219
    v_mul_f32 v220, s38, v220
    v_mul_f32 v221, s38, v221
    v_cvt_pk_bf16_f32 v218, v218, v219
    v_cvt_pk_bf16_f32 v220, v220, v221
    v_accvgpr_write_b32 a114, v218
    v_accvgpr_write_b32 a115, v220
    v_lshlrev_b32 v218, 16, v164
    v_and_b32 v219, 0xffff0000, v164
    v_lshlrev_b32 v220, 16, v165
    v_and_b32 v221, 0xffff0000, v165
    v_mul_f32 v218, s38, v218
    v_mul_f32 v219, s38, v219
    v_mul_f32 v220, s38, v220
    v_mul_f32 v221, s38, v221
    v_cvt_pk_bf16_f32 v218, v218, v219
    v_cvt_pk_bf16_f32 v220, v220, v221
    v_accvgpr_write_b32 a116, v218
    v_accvgpr_write_b32 a117, v220
    v_lshlrev_b32 v218, 16, v166
    v_and_b32 v219, 0xffff0000, v166
    v_lshlrev_b32 v220, 16, v167
    v_and_b32 v221, 0xffff0000, v167
    v_mul_f32 v218, s38, v218
    v_mul_f32 v219, s38, v219
    v_mul_f32 v220, s38, v220
    v_mul_f32 v221, s38, v221
    v_cvt_pk_bf16_f32 v218, v218, v219
    v_cvt_pk_bf16_f32 v220, v220, v221
    v_accvgpr_write_b32 a118, v218
    v_accvgpr_write_b32 a119, v220
    v_lshlrev_b32 v218, 16, v168
    v_and_b32 v219, 0xffff0000, v168
    v_lshlrev_b32 v220, 16, v169
    v_and_b32 v221, 0xffff0000, v169
    v_mul_f32 v218, s38, v218
    v_mul_f32 v219, s38, v219
    v_mul_f32 v220, s38, v220
    v_mul_f32 v221, s38, v221
    v_cvt_pk_bf16_f32 v218, v218, v219
    v_cvt_pk_bf16_f32 v220, v220, v221
    v_accvgpr_write_b32 a120, v218
    v_accvgpr_write_b32 a121, v220
    v_lshlrev_b32 v218, 16, v170
    v_and_b32 v219, 0xffff0000, v170
    v_lshlrev_b32 v220, 16, v171
    v_and_b32 v221, 0xffff0000, v171
    v_mul_f32 v218, s38, v218
    v_mul_f32 v219, s38, v219
    v_mul_f32 v220, s38, v220
    v_mul_f32 v221, s38, v221
    v_cvt_pk_bf16_f32 v218, v218, v219
    v_cvt_pk_bf16_f32 v220, v220, v221
    v_accvgpr_write_b32 a122, v218
    v_accvgpr_write_b32 a123, v220
    v_lshlrev_b32 v218, 16, v172
    v_and_b32 v219, 0xffff0000, v172
    v_lshlrev_b32 v220, 16, v173
    v_and_b32 v221, 0xffff0000, v173
    v_mul_f32 v218, s38, v218
    v_mul_f32 v219, s38, v219
    v_mul_f32 v220, s38, v220
    v_mul_f32 v221, s38, v221
    v_cvt_pk_bf16_f32 v218, v218, v219
    v_cvt_pk_bf16_f32 v220, v220, v221
    v_accvgpr_write_b32 a124, v218
    v_accvgpr_write_b32 a125, v220
    v_lshlrev_b32 v218, 16, v174
    v_and_b32 v219, 0xffff0000, v174
    v_lshlrev_b32 v220, 16, v175
    v_and_b32 v221, 0xffff0000, v175
    v_mul_f32 v218, s38, v218
    v_mul_f32 v219, s38, v219
    v_mul_f32 v220, s38, v220
    v_mul_f32 v221, s38, v221
    v_cvt_pk_bf16_f32 v218, v218, v219
    v_cvt_pk_bf16_f32 v220, v220, v221
    v_accvgpr_write_b32 a126, v218
    v_accvgpr_write_b32 a127, v220
    v_mfma_f32_16x16x32_bf16 v[184:187], a[240:243], a[112:115], 0
    v_mfma_f32_16x16x32_bf16 v[184:187], a[244:247], a[116:119], v[184:187]
    v_mfma_f32_16x16x32_bf16 v[184:187], a[248:251], a[120:123], v[184:187]
    v_mfma_f32_16x16x32_bf16 v[184:187], a[252:255], a[124:127], v[184:187]
    s_nop 7
    v_max3_f32 v222, v184, v185, v186
    v_max_f32 v222, v222, v187
    v_mov_b32 v223, v222
    s_nop 1
    v_permlane32_swap_b32 v222, v223
    v_max_f32 v222, v222, v223
    v_mov_b32 v223, v222
    s_nop 1
    v_permlane16_swap_b32 v222, v223
    v_max_f32 v222, v222, v223
    v_sub_f32 v116, 0, v222
    v_sub_f32 v117, 0, v222
    v_sub_f32 v118, 0, v222
    v_sub_f32 v119, 0, v222
    v_add_f32 v184, v184, v116
    v_add_f32 v185, v185, v116
    v_add_f32 v186, v186, v116
    v_add_f32 v187, v187, v116
    v_mfma_f32_16x16x32_bf16 v[188:191], a[208:211], a[112:115], v[116:119]
    v_mfma_f32_16x16x32_bf16 v[188:191], a[212:215], a[116:119], v[188:191]
    v_mfma_f32_16x16x32_bf16 v[188:191], a[216:219], a[120:123], v[188:191]
    v_mfma_f32_16x16x32_bf16 v[188:191], a[220:223], a[124:127], v[188:191]
    v_exp_f32 v184, v184
    v_exp_f32 v185, v185
    v_exp_f32 v186, v186
    v_exp_f32 v187, v187
    v_add_f32 v193, v193, v184
    v_add_f32 v193, v193, v185
    v_add_f32 v193, v193, v186
    v_add_f32 v193, v193, v187
    v_cvt_pk_bf16_f32 v140, v184, v185
    v_cvt_pk_bf16_f32 v141, v186, v187
    v_exp_f32 v188, v188
    v_exp_f32 v189, v189
    v_exp_f32 v190, v190
    v_exp_f32 v191, v191
    v_add_f32 v193, v193, v188
    v_add_f32 v193, v193, v189
    v_add_f32 v193, v193, v190
    v_add_f32 v193, v193, v191
    v_cvt_pk_bf16_f32 v142, v188, v189
    v_cvt_pk_bf16_f32 v143, v190, v191
    s_waitcnt vmcnt(0)
    ds_read_b128 v[160:163], v10 offset:8192
    ds_read_b128 v[164:167], v11 offset:8192
    ds_read_b128 v[168:171], v12 offset:8192
    ds_read_b128 v[172:175], v13 offset:8192
    s_add_u32 m0, s78, 12288
    s_nop 0
    buffer_load_dwordx4 v210, s[12:15], s43 offen nt lds
    buffer_load_dwordx4 v211, s[12:15], s43 offen offset:1024 nt lds
    buffer_load_dwordx4 v212, s[12:15], s43 offen offset:2048 nt lds
    buffer_load_dwordx4 v213, s[12:15], s43 offen offset:3072 nt lds
    s_waitcnt lgkmcnt(0)
    v_lshlrev_b32 v218, 16, v160
    v_and_b32 v219, 0xffff0000, v160
    v_lshlrev_b32 v220, 16, v161
    v_and_b32 v221, 0xffff0000, v161
    v_mul_f32 v218, s38, v218
    v_mul_f32 v219, s38, v219
    v_mul_f32 v220, s38, v220
    v_mul_f32 v221, s38, v221
    v_cvt_pk_bf16_f32 v218, v218, v219
    v_cvt_pk_bf16_f32 v220, v220, v221
    v_accvgpr_write_b32 a128, v218
    v_accvgpr_write_b32 a129, v220
    v_lshlrev_b32 v218, 16, v162
    v_and_b32 v219, 0xffff0000, v162
    v_lshlrev_b32 v220, 16, v163
    v_and_b32 v221, 0xffff0000, v163
    v_mul_f32 v218, s38, v218
    v_mul_f32 v219, s38, v219
    v_mul_f32 v220, s38, v220
    v_mul_f32 v221, s38, v221
    v_cvt_pk_bf16_f32 v218, v218, v219
    v_cvt_pk_bf16_f32 v220, v220, v221
    v_accvgpr_write_b32 a130, v218
    v_accvgpr_write_b32 a131, v220
    v_lshlrev_b32 v218, 16, v164
    v_and_b32 v219, 0xffff0000, v164
    v_lshlrev_b32 v220, 16, v165
    v_and_b32 v221, 0xffff0000, v165
    v_mul_f32 v218, s38, v218
    v_mul_f32 v219, s38, v219
    v_mul_f32 v220, s38, v220
    v_mul_f32 v221, s38, v221
    v_cvt_pk_bf16_f32 v218, v218, v219
    v_cvt_pk_bf16_f32 v220, v220, v221
    v_accvgpr_write_b32 a132, v218
    v_accvgpr_write_b32 a133, v220
    v_lshlrev_b32 v218, 16, v166
    v_and_b32 v219, 0xffff0000, v166
    v_lshlrev_b32 v220, 16, v167
    v_and_b32 v221, 0xffff0000, v167
    v_mul_f32 v218, s38, v218
    v_mul_f32 v219, s38, v219
    v_mul_f32 v220, s38, v220
    v_mul_f32 v221, s38, v221
    v_cvt_pk_bf16_f32 v218, v218, v219
    v_cvt_pk_bf16_f32 v220, v220, v221
    v_accvgpr_write_b32 a134, v218
    v_accvgpr_write_b32 a135, v220
    v_lshlrev_b32 v218, 16, v168
    v_and_b32 v219, 0xffff0000, v168
    v_lshlrev_b32 v220, 16, v169
    v_and_b32 v221, 0xffff0000, v169
    v_mul_f32 v218, s38, v218
    v_mul_f32 v219, s38, v219
    v_mul_f32 v220, s38, v220
    v_mul_f32 v221, s38, v221
    v_cvt_pk_bf16_f32 v218, v218, v219
    v_cvt_pk_bf16_f32 v220, v220, v221
    v_accvgpr_write_b32 a136, v218
    v_accvgpr_write_b32 a137, v220
    v_lshlrev_b32 v218, 16, v170
    v_and_b32 v219, 0xffff0000, v170
    v_lshlrev_b32 v220, 16, v171
    v_and_b32 v221, 0xffff0000, v171
    v_mul_f32 v218, s38, v218
    v_mul_f32 v219, s38, v219
    v_mul_f32 v220, s38, v220
    v_mul_f32 v221, s38, v221
    v_cvt_pk_bf16_f32 v218, v218, v219
    v_cvt_pk_bf16_f32 v220, v220, v221
    v_accvgpr_write_b32 a138, v218
    v_accvgpr_write_b32 a139, v220
    v_lshlrev_b32 v218, 16, v172
    v_and_b32 v219, 0xffff0000, v172
    v_lshlrev_b32 v220, 16, v173
    v_and_b32 v221, 0xffff0000, v173
    v_mul_f32 v218, s38, v218
    v_mul_f32 v219, s38, v219
    v_mul_f32 v220, s38, v220
    v_mul_f32 v221, s38, v221
    v_cvt_pk_bf16_f32 v218, v218, v219
    v_cvt_pk_bf16_f32 v220, v220, v221
    v_accvgpr_write_b32 a140, v218
    v_accvgpr_write_b32 a141, v220
    v_lshlrev_b32 v218, 16, v174
    v_and_b32 v219, 0xffff0000, v174
    v_lshlrev_b32 v220, 16, v175
    v_and_b32 v221, 0xffff0000, v175
    v_mul_f32 v218, s38, v218
    v_mul_f32 v219, s38, v219
    v_mul_f32 v220, s38, v220
    v_mul_f32 v221, s38, v221
    v_cvt_pk_bf16_f32 v218, v218, v219
    v_cvt_pk_bf16_f32 v220, v220, v221
    v_accvgpr_write_b32 a142, v218
    v_accvgpr_write_b32 a143, v220
    v_mfma_f32_16x16x32_bf16 v[184:187], a[240:243], a[128:131], 0
    v_mfma_f32_16x16x32_bf16 v[184:187], a[244:247], a[132:135], v[184:187]
    v_mfma_f32_16x16x32_bf16 v[184:187], a[248:251], a[136:139], v[184:187]
    v_mfma_f32_16x16x32_bf16 v[184:187], a[252:255], a[140:143], v[184:187]
    s_nop 7
    v_max3_f32 v222, v184, v185, v186
    v_max_f32 v222, v222, v187
    v_mov_b32 v223, v222
    s_nop 1
    v_permlane32_swap_b32 v222, v223
    v_max_f32 v222, v222, v223
    v_mov_b32 v223, v222
    s_nop 1
    v_permlane16_swap_b32 v222, v223
    v_max_f32 v222, v222, v223
    v_sub_f32 v120, 0, v222
    v_sub_f32 v121, 0, v222
    v_sub_f32 v122, 0, v222
    v_sub_f32 v123, 0, v222
    v_add_f32 v184, v184, v120
    v_add_f32 v185, v185, v120
    v_add_f32 v186, v186, v120
    v_add_f32 v187, v187, v120
    v_mfma_f32_16x16x32_bf16 v[188:191], a[208:211], a[128:131], v[120:123]
    v_mfma_f32_16x16x32_bf16 v[188:191], a[212:215], a[132:135], v[188:191]
    v_mfma_f32_16x16x32_bf16 v[188:191], a[216:219], a[136:139], v[188:191]
    v_mfma_f32_16x16x32_bf16 v[188:191], a[220:223], a[140:143], v[188:191]
    v_exp_f32 v184, v184
    v_exp_f32 v185, v185
    v_exp_f32 v186, v186
    v_exp_f32 v187, v187
    v_add_f32 v194, v194, v184
    v_add_f32 v194, v194, v185
    v_add_f32 v194, v194, v186
    v_add_f32 v194, v194, v187
    v_cvt_pk_bf16_f32 v144, v184, v185
    v_cvt_pk_bf16_f32 v145, v186, v187
    v_exp_f32 v188, v188
    v_exp_f32 v189, v189
    v_exp_f32 v190, v190
    v_exp_f32 v191, v191
    v_add_f32 v194, v194, v188
    v_add_f32 v194, v194, v189
    v_add_f32 v194, v194, v190
    v_add_f32 v194, v194, v191
    v_cvt_pk_bf16_f32 v146, v188, v189
    v_cvt_pk_bf16_f32 v147, v190, v191
    s_waitcnt vmcnt(0)
    ds_read_b128 v[160:163], v10 offset:12288
    ds_read_b128 v[164:167], v11 offset:12288
    ds_read_b128 v[168:171], v12 offset:12288
    ds_read_b128 v[172:175], v13 offset:12288
    s_add_u32 m0, s78, 16384
    s_nop 0
    buffer_load_dwordx4 v210, s[12:15], s44 offen nt lds
    buffer_load_dwordx4 v211, s[12:15], s44 offen offset:1024 nt lds
    buffer_load_dwordx4 v212, s[12:15], s44 offen offset:2048 nt lds
    buffer_load_dwordx4 v213, s[12:15], s44 offen offset:3072 nt lds
    s_add_u32 m0, s78, 0
    s_nop 0
    buffer_load_dwordx4 v210, s[12:15], s45 offen nt lds
    buffer_load_dwordx4 v211, s[12:15], s45 offen offset:1024 nt lds
    buffer_load_dwordx4 v212, s[12:15], s45 offen offset:2048 nt lds
    buffer_load_dwordx4 v213, s[12:15], s45 offen offset:3072 nt lds
    s_waitcnt lgkmcnt(0)
    v_lshlrev_b32 v218, 16, v160
    v_and_b32 v219, 0xffff0000, v160
    v_lshlrev_b32 v220, 16, v161
    v_and_b32 v221, 0xffff0000, v161
    v_mul_f32 v218, s38, v218
    v_mul_f32 v219, s38, v219
    v_mul_f32 v220, s38, v220
    v_mul_f32 v221, s38, v221
    v_cvt_pk_bf16_f32 v218, v218, v219
    v_cvt_pk_bf16_f32 v220, v220, v221
    v_accvgpr_write_b32 a144, v218
    v_accvgpr_write_b32 a145, v220
    v_lshlrev_b32 v218, 16, v162
    v_and_b32 v219, 0xffff0000, v162
    v_lshlrev_b32 v220, 16, v163
    v_and_b32 v221, 0xffff0000, v163
    v_mul_f32 v218, s38, v218
    v_mul_f32 v219, s38, v219
    v_mul_f32 v220, s38, v220
    v_mul_f32 v221, s38, v221
    v_cvt_pk_bf16_f32 v218, v218, v219
    v_cvt_pk_bf16_f32 v220, v220, v221
    v_accvgpr_write_b32 a146, v218
    v_accvgpr_write_b32 a147, v220
    v_lshlrev_b32 v218, 16, v164
    v_and_b32 v219, 0xffff0000, v164
    v_lshlrev_b32 v220, 16, v165
    v_and_b32 v221, 0xffff0000, v165
    v_mul_f32 v218, s38, v218
    v_mul_f32 v219, s38, v219
    v_mul_f32 v220, s38, v220
    v_mul_f32 v221, s38, v221
    v_cvt_pk_bf16_f32 v218, v218, v219
    v_cvt_pk_bf16_f32 v220, v220, v221
    v_accvgpr_write_b32 a148, v218
    v_accvgpr_write_b32 a149, v220
    v_lshlrev_b32 v218, 16, v166
    v_and_b32 v219, 0xffff0000, v166
    v_lshlrev_b32 v220, 16, v167
    v_and_b32 v221, 0xffff0000, v167
    v_mul_f32 v218, s38, v218
    v_mul_f32 v219, s38, v219
    v_mul_f32 v220, s38, v220
    v_mul_f32 v221, s38, v221
    v_cvt_pk_bf16_f32 v218, v218, v219
    v_cvt_pk_bf16_f32 v220, v220, v221
    v_accvgpr_write_b32 a150, v218
    v_accvgpr_write_b32 a151, v220
    v_lshlrev_b32 v218, 16, v168
    v_and_b32 v219, 0xffff0000, v168
    v_lshlrev_b32 v220, 16, v169
    v_and_b32 v221, 0xffff0000, v169
    v_mul_f32 v218, s38, v218
    v_mul_f32 v219, s38, v219
    v_mul_f32 v220, s38, v220
    v_mul_f32 v221, s38, v221
    v_cvt_pk_bf16_f32 v218, v218, v219
    v_cvt_pk_bf16_f32 v220, v220, v221
    v_accvgpr_write_b32 a152, v218
    v_accvgpr_write_b32 a153, v220
    v_lshlrev_b32 v218, 16, v170
    v_and_b32 v219, 0xffff0000, v170
    v_lshlrev_b32 v220, 16, v171
    v_and_b32 v221, 0xffff0000, v171
    v_mul_f32 v218, s38, v218
    v_mul_f32 v219, s38, v219
    v_mul_f32 v220, s38, v220
    v_mul_f32 v221, s38, v221
    v_cvt_pk_bf16_f32 v218, v218, v219
    v_cvt_pk_bf16_f32 v220, v220, v221
    v_accvgpr_write_b32 a154, v218
    v_accvgpr_write_b32 a155, v220
    v_lshlrev_b32 v218, 16, v172
    v_and_b32 v219, 0xffff0000, v172
    v_lshlrev_b32 v220, 16, v173
    v_and_b32 v221, 0xffff0000, v173
    v_mul_f32 v218, s38, v218
    v_mul_f32 v219, s38, v219
    v_mul_f32 v220, s38, v220
    v_mul_f32 v221, s38, v221
    v_cvt_pk_bf16_f32 v218, v218, v219
    v_cvt_pk_bf16_f32 v220, v220, v221
    v_accvgpr_write_b32 a156, v218
    v_accvgpr_write_b32 a157, v220
    v_lshlrev_b32 v218, 16, v174
    v_and_b32 v219, 0xffff0000, v174
    v_lshlrev_b32 v220, 16, v175
    v_and_b32 v221, 0xffff0000, v175
    v_mul_f32 v218, s38, v218
    v_mul_f32 v219, s38, v219
    v_mul_f32 v220, s38, v220
    v_mul_f32 v221, s38, v221
    v_cvt_pk_bf16_f32 v218, v218, v219
    v_cvt_pk_bf16_f32 v220, v220, v221
    v_accvgpr_write_b32 a158, v218
    v_accvgpr_write_b32 a159, v220
    v_mfma_f32_16x16x32_bf16 v[184:187], a[240:243], a[144:147], 0
    v_mfma_f32_16x16x32_bf16 v[184:187], a[244:247], a[148:151], v[184:187]
    v_mfma_f32_16x16x32_bf16 v[184:187], a[248:251], a[152:155], v[184:187]
    v_mfma_f32_16x16x32_bf16 v[184:187], a[252:255], a[156:159], v[184:187]
    s_nop 7
    v_max3_f32 v222, v184, v185, v186
    v_max_f32 v222, v222, v187
    v_mov_b32 v223, v222
    s_nop 1
    v_permlane32_swap_b32 v222, v223
    v_max_f32 v222, v222, v223
    v_mov_b32 v223, v222
    s_nop 1
    v_permlane16_swap_b32 v222, v223
    v_max_f32 v222, v222, v223
    v_sub_f32 v124, 0, v222
    v_sub_f32 v125, 0, v222
    v_sub_f32 v126, 0, v222
    v_sub_f32 v127, 0, v222
    v_add_f32 v184, v184, v124
    v_add_f32 v185, v185, v124
    v_add_f32 v186, v186, v124
    v_add_f32 v187, v187, v124
    v_mfma_f32_16x16x32_bf16 v[188:191], a[208:211], a[144:147], v[124:127]
    v_mfma_f32_16x16x32_bf16 v[188:191], a[212:215], a[148:151], v[188:191]
    v_mfma_f32_16x16x32_bf16 v[188:191], a[216:219], a[152:155], v[188:191]
    v_mfma_f32_16x16x32_bf16 v[188:191], a[220:223], a[156:159], v[188:191]
    v_exp_f32 v184, v184
    v_exp_f32 v185, v185
    v_exp_f32 v186, v186
    v_exp_f32 v187, v187
    v_add_f32 v195, v195, v184
    v_add_f32 v195, v195, v185
    v_add_f32 v195, v195, v186
    v_add_f32 v195, v195, v187
    v_cvt_pk_bf16_f32 v148, v184, v185
    v_cvt_pk_bf16_f32 v149, v186, v187
    v_exp_f32 v188, v188
    v_exp_f32 v189, v189
    v_exp_f32 v190, v190
    v_exp_f32 v191, v191
    v_add_f32 v195, v195, v188
    v_add_f32 v195, v195, v189
    v_add_f32 v195, v195, v190
    v_add_f32 v195, v195, v191
    v_cvt_pk_bf16_f32 v150, v188, v189
    v_cvt_pk_bf16_f32 v151, v190, v191
    s_waitcnt vmcnt(4)
    ds_read_b128 v[160:163], v10 offset:16384
    ds_read_b128 v[164:167], v11 offset:16384
    ds_read_b128 v[168:171], v12 offset:16384
    ds_read_b128 v[172:175], v13 offset:16384
    s_mov_b32 m0, s77
    s_nop 0
    buffer_load_dwordx4 v253, s[20:23], s77 offen nt lds
    buffer_load_dwordx4 v254, s[20:23], s77 offen offset:1024 nt lds
    s_add_u32 m0, s77, 65536
    s_nop 0
    buffer_load_dwordx4 v214, s[24:27], s77 offen nt lds
    buffer_load_dwordx4 v215, s[24:27], s77 offen offset:1024 nt lds
    s_add_u32 s47, s77, 8192
    s_mov_b32 m0, s47
    s_nop 0
    buffer_load_dwordx4 v253, s[20:23], s47 offen nt lds
    buffer_load_dwordx4 v254, s[20:23], s47 offen offset:1024 nt lds
    s_add_u32 m0, s47, 65536
    s_nop 0
    buffer_load_dwordx4 v214, s[24:27], s47 offen nt lds
    buffer_load_dwordx4 v215, s[24:27], s47 offen offset:1024 nt lds
    s_waitcnt lgkmcnt(0)
    v_lshlrev_b32 v218, 16, v160
    v_and_b32 v219, 0xffff0000, v160
    v_lshlrev_b32 v220, 16, v161
    v_and_b32 v221, 0xffff0000, v161
    v_mul_f32 v218, s38, v218
    v_mul_f32 v219, s38, v219
    v_mul_f32 v220, s38, v220
    v_mul_f32 v221, s38, v221
    v_cvt_pk_bf16_f32 v218, v218, v219
    v_cvt_pk_bf16_f32 v220, v220, v221
    v_accvgpr_write_b32 a160, v218
    v_accvgpr_write_b32 a161, v220
    v_lshlrev_b32 v218, 16, v162
    v_and_b32 v219, 0xffff0000, v162
    v_lshlrev_b32 v220, 16, v163
    v_and_b32 v221, 0xffff0000, v163
    v_mul_f32 v218, s38, v218
    v_mul_f32 v219, s38, v219
    v_mul_f32 v220, s38, v220
    v_mul_f32 v221, s38, v221
    v_cvt_pk_bf16_f32 v218, v218, v219
    v_cvt_pk_bf16_f32 v220, v220, v221
    v_accvgpr_write_b32 a162, v218
    v_accvgpr_write_b32 a163, v220
    v_lshlrev_b32 v218, 16, v164
    v_and_b32 v219, 0xffff0000, v164
    v_lshlrev_b32 v220, 16, v165
    v_and_b32 v221, 0xffff0000, v165
    v_mul_f32 v218, s38, v218
    v_mul_f32 v219, s38, v219
    v_mul_f32 v220, s38, v220
    v_mul_f32 v221, s38, v221
    v_cvt_pk_bf16_f32 v218, v218, v219
    v_cvt_pk_bf16_f32 v220, v220, v221
    v_accvgpr_write_b32 a164, v218
    v_accvgpr_write_b32 a165, v220
    v_lshlrev_b32 v218, 16, v166
    v_and_b32 v219, 0xffff0000, v166
    v_lshlrev_b32 v220, 16, v167
    v_and_b32 v221, 0xffff0000, v167
    v_mul_f32 v218, s38, v218
    v_mul_f32 v219, s38, v219
    v_mul_f32 v220, s38, v220
    v_mul_f32 v221, s38, v221
    v_cvt_pk_bf16_f32 v218, v218, v219
    v_cvt_pk_bf16_f32 v220, v220, v221
    v_accvgpr_write_b32 a166, v218
    v_accvgpr_write_b32 a167, v220
    v_lshlrev_b32 v218, 16, v168
    v_and_b32 v219, 0xffff0000, v168
    v_lshlrev_b32 v220, 16, v169
    v_and_b32 v221, 0xffff0000, v169
    v_mul_f32 v218, s38, v218
    v_mul_f32 v219, s38, v219
    v_mul_f32 v220, s38, v220
    v_mul_f32 v221, s38, v221
    v_cvt_pk_bf16_f32 v218, v218, v219
    v_cvt_pk_bf16_f32 v220, v220, v221
    v_accvgpr_write_b32 a168, v218
    v_accvgpr_write_b32 a169, v220
    v_lshlrev_b32 v218, 16, v170
    v_and_b32 v219, 0xffff0000, v170
    v_lshlrev_b32 v220, 16, v171
    v_and_b32 v221, 0xffff0000, v171
    v_mul_f32 v218, s38, v218
    v_mul_f32 v219, s38, v219
    v_mul_f32 v220, s38, v220
    v_mul_f32 v221, s38, v221
    v_cvt_pk_bf16_f32 v218, v218, v219
    v_cvt_pk_bf16_f32 v220, v220, v221
    v_accvgpr_write_b32 a170, v218
    v_accvgpr_write_b32 a171, v220
    v_lshlrev_b32 v218, 16, v172
    v_and_b32 v219, 0xffff0000, v172
    v_lshlrev_b32 v220, 16, v173
    v_and_b32 v221, 0xffff0000, v173
    v_mul_f32 v218, s38, v218
    v_mul_f32 v219, s38, v219
    v_mul_f32 v220, s38, v220
    v_mul_f32 v221, s38, v221
    v_cvt_pk_bf16_f32 v218, v218, v219
    v_cvt_pk_bf16_f32 v220, v220, v221
    v_accvgpr_write_b32 a172, v218
    v_accvgpr_write_b32 a173, v220
    v_lshlrev_b32 v218, 16, v174
    v_and_b32 v219, 0xffff0000, v174
    v_lshlrev_b32 v220, 16, v175
    v_and_b32 v221, 0xffff0000, v175
    v_mul_f32 v218, s38, v218
    v_mul_f32 v219, s38, v219
    v_mul_f32 v220, s38, v220
    v_mul_f32 v221, s38, v221
    v_cvt_pk_bf16_f32 v218, v218, v219
    v_cvt_pk_bf16_f32 v220, v220, v221
    v_accvgpr_write_b32 a174, v218
    v_accvgpr_write_b32 a175, v220
    v_mfma_f32_16x16x32_bf16 v[184:187], a[240:243], a[160:163], 0
    v_mfma_f32_16x16x32_bf16 v[184:187], a[244:247], a[164:167], v[184:187]
    v_mfma_f32_16x16x32_bf16 v[184:187], a[248:251], a[168:171], v[184:187]
    v_mfma_f32_16x16x32_bf16 v[184:187], a[252:255], a[172:175], v[184:187]
    s_nop 7
    v_max3_f32 v222, v184, v185, v186
    v_max_f32 v222, v222, v187
    v_mov_b32 v223, v222
    s_nop 1
    v_permlane32_swap_b32 v222, v223
    v_max_f32 v222, v222, v223
    v_mov_b32 v223, v222
    s_nop 1
    v_permlane16_swap_b32 v222, v223
    v_max_f32 v222, v222, v223
    v_sub_f32 v128, 0, v222
    v_sub_f32 v129, 0, v222
    v_sub_f32 v130, 0, v222
    v_sub_f32 v131, 0, v222
    v_add_f32 v184, v184, v128
    v_add_f32 v185, v185, v128
    v_add_f32 v186, v186, v128
    v_add_f32 v187, v187, v128
    v_mfma_f32_16x16x32_bf16 v[188:191], a[208:211], a[160:163], v[128:131]
    v_mfma_f32_16x16x32_bf16 v[188:191], a[212:215], a[164:167], v[188:191]
    v_mfma_f32_16x16x32_bf16 v[188:191], a[216:219], a[168:171], v[188:191]
    v_mfma_f32_16x16x32_bf16 v[188:191], a[220:223], a[172:175], v[188:191]
    v_exp_f32 v184, v184
    v_exp_f32 v185, v185
    v_exp_f32 v186, v186
    v_exp_f32 v187, v187
    v_add_f32 v196, v196, v184
    v_add_f32 v196, v196, v185
    v_add_f32 v196, v196, v186
    v_add_f32 v196, v196, v187
    v_cvt_pk_bf16_f32 v152, v184, v185
    v_cvt_pk_bf16_f32 v153, v186, v187
    v_exp_f32 v188, v188
    v_exp_f32 v189, v189
    v_exp_f32 v190, v190
    v_exp_f32 v191, v191
    v_add_f32 v196, v196, v188
    v_add_f32 v196, v196, v189
    v_add_f32 v196, v196, v190
    v_add_f32 v196, v196, v191
    v_cvt_pk_bf16_f32 v154, v188, v189
    v_cvt_pk_bf16_f32 v155, v190, v191
    s_waitcnt vmcnt(8)
    ds_read_b128 v[160:163], v10
    ds_read_b128 v[164:167], v11
    ds_read_b128 v[168:171], v12
    ds_read_b128 v[172:175], v13
    s_add_u32 s33, s34, 16384
    s_add_u32 s80, s20, s33
    s_addc_u32 s81, s21, 0
    s_sub_u32 s82, 512000, s33
    s_mov_b32 s83, 0x20000
    s_add_u32 s84, s24, s33
    s_addc_u32 s85, s25, 0
    s_sub_u32 s86, 524288, s33
    s_mov_b32 s87, 0x20000
    s_add_u32 m0, s34, 16384
    s_nop 0
    buffer_load_dwordx4 v210, s[80:83], 0 offen nt lds
    buffer_load_dwordx4 v211, s[80:83], 0 offen offset:1024 nt lds
    buffer_load_dwordx4 v212, s[80:83], 0 offen offset:2048 nt lds
    buffer_load_dwordx4 v213, s[80:83], 0 offen offset:3072 nt lds
    s_add_u32 s80, s80, 16384
    s_addc_u32 s81, s81, 0
    s_sub_i32 s82, s82, 16384
    s_max_i32 s82, s82, 0
    s_add_u32 m0, s35, 16384
    s_nop 0
    buffer_load_dwordx4 v214, s[84:87], 0 offen nt lds
    buffer_load_dwordx4 v215, s[84:87], 0 offen offset:1024 nt lds
    buffer_load_dwordx4 v214, s[84:87], 0 offen offset:2048 nt lds
    buffer_load_dwordx4 v215, s[84:87], 0 offen offset:3072 nt lds
    s_add_u32 s84, s84, 16384
    s_addc_u32 s85, s85, 0
    s_sub_i32 s86, s86, 16384
    s_max_i32 s86, s86, 0
    s_waitcnt lgkmcnt(0)
    v_lshlrev_b32 v218, 16, v160
    v_and_b32 v219, 0xffff0000, v160
    v_lshlrev_b32 v220, 16, v161
    v_and_b32 v221, 0xffff0000, v161
    v_mul_f32 v218, s38, v218
    v_mul_f32 v219, s38, v219
    v_mul_f32 v220, s38, v220
    v_mul_f32 v221, s38, v221
    v_cvt_pk_bf16_f32 v218, v218, v219
    v_cvt_pk_bf16_f32 v220, v220, v221
    v_accvgpr_write_b32 a176, v218
    v_accvgpr_write_b32 a177, v220
    v_lshlrev_b32 v218, 16, v162
    v_and_b32 v219, 0xffff0000, v162
    v_lshlrev_b32 v220, 16, v163
    v_and_b32 v221, 0xffff0000, v163
    v_mul_f32 v218, s38, v218
    v_mul_f32 v219, s38, v219
    v_mul_f32 v220, s38, v220
    v_mul_f32 v221, s38, v221
    v_cvt_pk_bf16_f32 v218, v218, v219
    v_cvt_pk_bf16_f32 v220, v220, v221
    v_accvgpr_write_b32 a178, v218
    v_accvgpr_write_b32 a179, v220
    v_lshlrev_b32 v218, 16, v164
    v_and_b32 v219, 0xffff0000, v164
    v_lshlrev_b32 v220, 16, v165
    v_and_b32 v221, 0xffff0000, v165
    v_mul_f32 v218, s38, v218
    v_mul_f32 v219, s38, v219
    v_mul_f32 v220, s38, v220
    v_mul_f32 v221, s38, v221
    v_cvt_pk_bf16_f32 v218, v218, v219
    v_cvt_pk_bf16_f32 v220, v220, v221
    v_accvgpr_write_b32 a180, v218
    v_accvgpr_write_b32 a181, v220
    v_lshlrev_b32 v218, 16, v166
    v_and_b32 v219, 0xffff0000, v166
    v_lshlrev_b32 v220, 16, v167
    v_and_b32 v221, 0xffff0000, v167
    v_mul_f32 v218, s38, v218
    v_mul_f32 v219, s38, v219
    v_mul_f32 v220, s38, v220
    v_mul_f32 v221, s38, v221
    v_cvt_pk_bf16_f32 v218, v218, v219
    v_cvt_pk_bf16_f32 v220, v220, v221
    v_accvgpr_write_b32 a182, v218
    v_accvgpr_write_b32 a183, v220
    v_lshlrev_b32 v218, 16, v168
    v_and_b32 v219, 0xffff0000, v168
    v_lshlrev_b32 v220, 16, v169
    v_and_b32 v221, 0xffff0000, v169
    v_mul_f32 v218, s38, v218
    v_mul_f32 v219, s38, v219
    v_mul_f32 v220, s38, v220
    v_mul_f32 v221, s38, v221
    v_cvt_pk_bf16_f32 v218, v218, v219
    v_cvt_pk_bf16_f32 v220, v220, v221
    v_accvgpr_write_b32 a184, v218
    v_accvgpr_write_b32 a185, v220
    v_lshlrev_b32 v218, 16, v170
    v_and_b32 v219, 0xffff0000, v170
    v_lshlrev_b32 v220, 16, v171
    v_and_b32 v221, 0xffff0000, v171
    v_mul_f32 v218, s38, v218
    v_mul_f32 v219, s38, v219
    v_mul_f32 v220, s38, v220
    v_mul_f32 v221, s38, v221
    v_cvt_pk_bf16_f32 v218, v218, v219
    v_cvt_pk_bf16_f32 v220, v220, v221
    v_accvgpr_write_b32 a186, v218
    v_accvgpr_write_b32 a187, v220
    v_lshlrev_b32 v218, 16, v172
    v_and_b32 v219, 0xffff0000, v172
    v_lshlrev_b32 v220, 16, v173
    v_and_b32 v221, 0xffff0000, v173
    v_mul_f32 v218, s38, v218
    v_mul_f32 v219, s38, v219
    v_mul_f32 v220, s38, v220
    v_mul_f32 v221, s38, v221
    v_cvt_pk_bf16_f32 v218, v218, v219
    v_cvt_pk_bf16_f32 v220, v220, v221
    v_accvgpr_write_b32 a188, v218
    v_accvgpr_write_b32 a189, v220
    v_lshlrev_b32 v218, 16, v174
    v_and_b32 v219, 0xffff0000, v174
    v_lshlrev_b32 v220, 16, v175
    v_and_b32 v221, 0xffff0000, v175
    v_mul_f32 v218, s38, v218
    v_mul_f32 v219, s38, v219
    v_mul_f32 v220, s38, v220
    v_mul_f32 v221, s38, v221
    v_cvt_pk_bf16_f32 v218, v218, v219
    v_cvt_pk_bf16_f32 v220, v220, v221
    v_accvgpr_write_b32 a190, v218
    v_accvgpr_write_b32 a191, v220
    v_mfma_f32_16x16x32_bf16 v[184:187], a[240:243], a[176:179], 0
    v_mfma_f32_16x16x32_bf16 v[184:187], a[244:247], a[180:183], v[184:187]
    v_mfma_f32_16x16x32_bf16 v[184:187], a[248:251], a[184:187], v[184:187]
    v_mfma_f32_16x16x32_bf16 v[184:187], a[252:255], a[188:191], v[184:187]
    s_nop 7
    v_max3_f32 v222, v184, v185, v186
    v_max_f32 v222, v222, v187
    v_mov_b32 v223, v222
    s_nop 1
    v_permlane32_swap_b32 v222, v223
    v_max_f32 v222, v222, v223
    v_mov_b32 v223, v222
    s_nop 1
    v_permlane16_swap_b32 v222, v223
    v_max_f32 v222, v222, v223
    v_sub_f32 v132, 0, v222
    v_sub_f32 v133, 0, v222
    v_sub_f32 v134, 0, v222
    v_sub_f32 v135, 0, v222
    v_add_f32 v184, v184, v132
    v_add_f32 v185, v185, v132
    v_add_f32 v186, v186, v132
    v_add_f32 v187, v187, v132
    v_mfma_f32_16x16x32_bf16 v[188:191], a[208:211], a[176:179], v[132:135]
    v_mfma_f32_16x16x32_bf16 v[188:191], a[212:215], a[180:183], v[188:191]
    v_mfma_f32_16x16x32_bf16 v[188:191], a[216:219], a[184:187], v[188:191]
    v_mfma_f32_16x16x32_bf16 v[188:191], a[220:223], a[188:191], v[188:191]
    v_exp_f32 v184, v184
    v_exp_f32 v185, v185
    v_exp_f32 v186, v186
    v_exp_f32 v187, v187
    v_add_f32 v197, v197, v184
    v_add_f32 v197, v197, v185
    v_add_f32 v197, v197, v186
    v_add_f32 v197, v197, v187
    v_cvt_pk_bf16_f32 v156, v184, v185
    v_cvt_pk_bf16_f32 v157, v186, v187
    v_exp_f32 v188, v188
    v_exp_f32 v189, v189
    v_exp_f32 v190, v190
    v_exp_f32 v191, v191
    v_add_f32 v197, v197, v188
    v_add_f32 v197, v197, v189
    v_add_f32 v197, v197, v190
    v_add_f32 v197, v197, v191
    v_cvt_pk_bf16_f32 v158, v188, v189
    v_cvt_pk_bf16_f32 v159, v190, v191
    s_add_u32 s46, s34, 32768
    v_and_b32 v226, 63, v0
    v_lshlrev_b32 v13, 4, v226
    v_add_u32 v9, s46, v210
    v_add_u32 v10, s46, v211
    v_add_u32 v11, s46, v212
    v_add_u32 v12, s46, v213
    s_branch L_main_entry
L_safe:
    s_waitcnt vmcnt(0) lgkmcnt(0)
    s_barrier
    v_mov_b32 v242, 0xff800000
    v_mov_b32 v243, 0xff800000
    v_mov_b32 v244, 0xff800000
    v_mov_b32 v245, 0xff800000
    v_mov_b32 v246, 0xff800000
    v_mov_b32 v247, 0xff800000
    s_mov_b32 s33, s34
    s_mov_b32 s36, 32
L_safe_loop:
    s_mov_b32 m0, s34
    s_nop 0
    buffer_load_dwordx4 v210, s[16:19], s33 offen lds
    buffer_load_dwordx4 v211, s[16:19], s33 offen offset:1024 lds
    buffer_load_dwordx4 v212, s[16:19], s33 offen offset:2048 lds
    buffer_load_dwordx4 v213, s[16:19], s33 offen offset:3072 lds
    s_waitcnt vmcnt(0)
    s_barrier
    ds_read_b128 a[192:195], v198
    ds_read_b128 a[196:199], v199
    ds_read_b128 a[200:203], v200
    ds_read_b128 a[204:207], v201
    s_waitcnt lgkmcnt(0)
    v_mfma_f32_16x16x32_bf16 v[184:187], a[192:195], a[96:99], 0
    v_mfma_f32_16x16x32_bf16 v[184:187], a[196:199], a[100:103], v[184:187]
    v_mfma_f32_16x16x32_bf16 v[184:187], a[200:203], a[104:107], v[184:187]
    v_mfma_f32_16x16x32_bf16 v[184:187], a[204:207], a[108:111], v[184:187]
    s_nop 7
    v_max3_f32 v242, v184, v185, v242
    v_max3_f32 v242, v186, v187, v242
    v_mfma_f32_16x16x32_bf16 v[188:191], a[192:195], a[112:115], 0
    v_mfma_f32_16x16x32_bf16 v[188:191], a[196:199], a[116:119], v[188:191]
    v_mfma_f32_16x16x32_bf16 v[188:191], a[200:203], a[120:123], v[188:191]
    v_mfma_f32_16x16x32_bf16 v[188:191], a[204:207], a[124:127], v[188:191]
    s_nop 7
    v_max3_f32 v243, v188, v189, v243
    v_max3_f32 v243, v190, v191, v243
    v_mfma_f32_16x16x32_bf16 v[184:187], a[192:195], a[128:131], 0
    v_mfma_f32_16x16x32_bf16 v[184:187], a[196:199], a[132:135], v[184:187]
    v_mfma_f32_16x16x32_bf16 v[184:187], a[200:203], a[136:139], v[184:187]
    v_mfma_f32_16x16x32_bf16 v[184:187], a[204:207], a[140:143], v[184:187]
    s_nop 7
    v_max3_f32 v244, v184, v185, v244
    v_max3_f32 v244, v186, v187, v244
    v_mfma_f32_16x16x32_bf16 v[188:191], a[192:195], a[144:147], 0
    v_mfma_f32_16x16x32_bf16 v[188:191], a[196:199], a[148:151], v[188:191]
    v_mfma_f32_16x16x32_bf16 v[188:191], a[200:203], a[152:155], v[188:191]
    v_mfma_f32_16x16x32_bf16 v[188:191], a[204:207], a[156:159], v[188:191]
    s_nop 7
    v_max3_f32 v245, v188, v189, v245
    v_max3_f32 v245, v190, v191, v245
    v_mfma_f32_16x16x32_bf16 v[184:187], a[192:195], a[160:163], 0
    v_mfma_f32_16x16x32_bf16 v[184:187], a[196:199], a[164:167], v[184:187]
    v_mfma_f32_16x16x32_bf16 v[184:187], a[200:203], a[168:171], v[184:187]
    v_mfma_f32_16x16x32_bf16 v[184:187], a[204:207], a[172:175], v[184:187]
    s_nop 7
    v_max3_f32 v246, v184, v185, v246
    v_max3_f32 v246, v186, v187, v246
    v_mfma_f32_16x16x32_bf16 v[188:191], a[192:195], a[176:179], 0
    v_mfma_f32_16x16x32_bf16 v[188:191], a[196:199], a[180:183], v[188:191]
    v_mfma_f32_16x16x32_bf16 v[188:191], a[200:203], a[184:187], v[188:191]
    v_mfma_f32_16x16x32_bf16 v[188:191], a[204:207], a[188:191], v[188:191]
    s_nop 7
    v_max3_f32 v247, v188, v189, v247
    v_max3_f32 v247, v190, v191, v247
    ds_read_b128 a[192:195], v198 offset:4096
    ds_read_b128 a[196:199], v199 offset:4096
    ds_read_b128 a[200:203], v200 offset:4096
    ds_read_b128 a[204:207], v201 offset:4096
    s_waitcnt lgkmcnt(0)
    v_mfma_f32_16x16x32_bf16 v[184:187], a[192:195], a[96:99], 0
    v_mfma_f32_16x16x32_bf16 v[184:187], a[196:199], a[100:103], v[184:187]
    v_mfma_f32_16x16x32_bf16 v[184:187], a[200:203], a[104:107], v[184:187]
    v_mfma_f32_16x16x32_bf16 v[184:187], a[204:207], a[108:111], v[184:187]
    s_nop 7
    v_max3_f32 v242, v184, v185, v242
    v_max3_f32 v242, v186, v187, v242
    v_mfma_f32_16x16x32_bf16 v[188:191], a[192:195], a[112:115], 0
    v_mfma_f32_16x16x32_bf16 v[188:191], a[196:199], a[116:119], v[188:191]
    v_mfma_f32_16x16x32_bf16 v[188:191], a[200:203], a[120:123], v[188:191]
    v_mfma_f32_16x16x32_bf16 v[188:191], a[204:207], a[124:127], v[188:191]
    s_nop 7
    v_max3_f32 v243, v188, v189, v243
    v_max3_f32 v243, v190, v191, v243
    v_mfma_f32_16x16x32_bf16 v[184:187], a[192:195], a[128:131], 0
    v_mfma_f32_16x16x32_bf16 v[184:187], a[196:199], a[132:135], v[184:187]
    v_mfma_f32_16x16x32_bf16 v[184:187], a[200:203], a[136:139], v[184:187]
    v_mfma_f32_16x16x32_bf16 v[184:187], a[204:207], a[140:143], v[184:187]
    s_nop 7
    v_max3_f32 v244, v184, v185, v244
    v_max3_f32 v244, v186, v187, v244
    v_mfma_f32_16x16x32_bf16 v[188:191], a[192:195], a[144:147], 0
    v_mfma_f32_16x16x32_bf16 v[188:191], a[196:199], a[148:151], v[188:191]
    v_mfma_f32_16x16x32_bf16 v[188:191], a[200:203], a[152:155], v[188:191]
    v_mfma_f32_16x16x32_bf16 v[188:191], a[204:207], a[156:159], v[188:191]
    s_nop 7
    v_max3_f32 v245, v188, v189, v245
    v_max3_f32 v245, v190, v191, v245
    v_mfma_f32_16x16x32_bf16 v[184:187], a[192:195], a[160:163], 0
    v_mfma_f32_16x16x32_bf16 v[184:187], a[196:199], a[164:167], v[184:187]
    v_mfma_f32_16x16x32_bf16 v[184:187], a[200:203], a[168:171], v[184:187]
    v_mfma_f32_16x16x32_bf16 v[184:187], a[204:207], a[172:175], v[184:187]
    s_nop 7
    v_max3_f32 v246, v184, v185, v246
    v_max3_f32 v246, v186, v187, v246
    v_mfma_f32_16x16x32_bf16 v[188:191], a[192:195], a[176:179], 0
    v_mfma_f32_16x16x32_bf16 v[188:191], a[196:199], a[180:183], v[188:191]
    v_mfma_f32_16x16x32_bf16 v[188:191], a[200:203], a[184:187], v[188:191]
    v_mfma_f32_16x16x32_bf16 v[188:191], a[204:207], a[188:191], v[188:191]
    s_nop 7
    v_max3_f32 v247, v188, v189, v247
    v_max3_f32 v247, v190, v191, v247
    ds_read_b128 a[192:195], v198 offset:8192
    ds_read_b128 a[196:199], v199 offset:8192
    ds_read_b128 a[200:203], v200 offset:8192
    ds_read_b128 a[204:207], v201 offset:8192
    s_waitcnt lgkmcnt(0)
    v_mfma_f32_16x16x32_bf16 v[184:187], a[192:195], a[96:99], 0
    v_mfma_f32_16x16x32_bf16 v[184:187], a[196:199], a[100:103], v[184:187]
    v_mfma_f32_16x16x32_bf16 v[184:187], a[200:203], a[104:107], v[184:187]
    v_mfma_f32_16x16x32_bf16 v[184:187], a[204:207], a[108:111], v[184:187]
    s_nop 7
    v_max3_f32 v242, v184, v185, v242
    v_max3_f32 v242, v186, v187, v242
    v_mfma_f32_16x16x32_bf16 v[188:191], a[192:195], a[112:115], 0
    v_mfma_f32_16x16x32_bf16 v[188:191], a[196:199], a[116:119], v[188:191]
    v_mfma_f32_16x16x32_bf16 v[188:191], a[200:203], a[120:123], v[188:191]
    v_mfma_f32_16x16x32_bf16 v[188:191], a[204:207], a[124:127], v[188:191]
    s_nop 7
    v_max3_f32 v243, v188, v189, v243
    v_max3_f32 v243, v190, v191, v243
    v_mfma_f32_16x16x32_bf16 v[184:187], a[192:195], a[128:131], 0
    v_mfma_f32_16x16x32_bf16 v[184:187], a[196:199], a[132:135], v[184:187]
    v_mfma_f32_16x16x32_bf16 v[184:187], a[200:203], a[136:139], v[184:187]
    v_mfma_f32_16x16x32_bf16 v[184:187], a[204:207], a[140:143], v[184:187]
    s_nop 7
    v_max3_f32 v244, v184, v185, v244
    v_max3_f32 v244, v186, v187, v244
    v_mfma_f32_16x16x32_bf16 v[188:191], a[192:195], a[144:147], 0
    v_mfma_f32_16x16x32_bf16 v[188:191], a[196:199], a[148:151], v[188:191]
    v_mfma_f32_16x16x32_bf16 v[188:191], a[200:203], a[152:155], v[188:191]
    v_mfma_f32_16x16x32_bf16 v[188:191], a[204:207], a[156:159], v[188:191]
    s_nop 7
    v_max3_f32 v245, v188, v189, v245
    v_max3_f32 v245, v190, v191, v245
    v_mfma_f32_16x16x32_bf16 v[184:187], a[192:195], a[160:163], 0
    v_mfma_f32_16x16x32_bf16 v[184:187], a[196:199], a[164:167], v[184:187]
    v_mfma_f32_16x16x32_bf16 v[184:187], a[200:203], a[168:171], v[184:187]
    v_mfma_f32_16x16x32_bf16 v[184:187], a[204:207], a[172:175], v[184:187]
    s_nop 7
    v_max3_f32 v246, v184, v185, v246
    v_max3_f32 v246, v186, v187, v246
    v_mfma_f32_16x16x32_bf16 v[188:191], a[192:195], a[176:179], 0
    v_mfma_f32_16x16x32_bf16 v[188:191], a[196:199], a[180:183], v[188:191]
    v_mfma_f32_16x16x32_bf16 v[188:191], a[200:203], a[184:187], v[188:191]
    v_mfma_f32_16x16x32_bf16 v[188:191], a[204:207], a[188:191], v[188:191]
    s_nop 7
    v_max3_f32 v247, v188, v189, v247
    v_max3_f32 v247, v190, v191, v247
    ds_read_b128 a[192:195], v198 offset:12288
    ds_read_b128 a[196:199], v199 offset:12288
    ds_read_b128 a[200:203], v200 offset:12288
    ds_read_b128 a[204:207], v201 offset:12288
    s_waitcnt lgkmcnt(0)
    v_mfma_f32_16x16x32_bf16 v[184:187], a[192:195], a[96:99], 0
    v_mfma_f32_16x16x32_bf16 v[184:187], a[196:199], a[100:103], v[184:187]
    v_mfma_f32_16x16x32_bf16 v[184:187], a[200:203], a[104:107], v[184:187]
    v_mfma_f32_16x16x32_bf16 v[184:187], a[204:207], a[108:111], v[184:187]
    s_nop 7
    v_max3_f32 v242, v184, v185, v242
    v_max3_f32 v242, v186, v187, v242
    v_mfma_f32_16x16x32_bf16 v[188:191], a[192:195], a[112:115], 0
    v_mfma_f32_16x16x32_bf16 v[188:191], a[196:199], a[116:119], v[188:191]
    v_mfma_f32_16x16x32_bf16 v[188:191], a[200:203], a[120:123], v[188:191]
    v_mfma_f32_16x16x32_bf16 v[188:191], a[204:207], a[124:127], v[188:191]
    s_nop 7
    v_max3_f32 v243, v188, v189, v243
    v_max3_f32 v243, v190, v191, v243
    v_mfma_f32_16x16x32_bf16 v[184:187], a[192:195], a[128:131], 0
    v_mfma_f32_16x16x32_bf16 v[184:187], a[196:199], a[132:135], v[184:187]
    v_mfma_f32_16x16x32_bf16 v[184:187], a[200:203], a[136:139], v[184:187]
    v_mfma_f32_16x16x32_bf16 v[184:187], a[204:207], a[140:143], v[184:187]
    s_nop 7
    v_max3_f32 v244, v184, v185, v244
    v_max3_f32 v244, v186, v187, v244
    v_mfma_f32_16x16x32_bf16 v[188:191], a[192:195], a[144:147], 0
    v_mfma_f32_16x16x32_bf16 v[188:191], a[196:199], a[148:151], v[188:191]
    v_mfma_f32_16x16x32_bf16 v[188:191], a[200:203], a[152:155], v[188:191]
    v_mfma_f32_16x16x32_bf16 v[188:191], a[204:207], a[156:159], v[188:191]
    s_nop 7
    v_max3_f32 v245, v188, v189, v245
    v_max3_f32 v245, v190, v191, v245
    v_mfma_f32_16x16x32_bf16 v[184:187], a[192:195], a[160:163], 0
    v_mfma_f32_16x16x32_bf16 v[184:187], a[196:199], a[164:167], v[184:187]
    v_mfma_f32_16x16x32_bf16 v[184:187], a[200:203], a[168:171], v[184:187]
    v_mfma_f32_16x16x32_bf16 v[184:187], a[204:207], a[172:175], v[184:187]
    s_nop 7
    v_max3_f32 v246, v184, v185, v246
    v_max3_f32 v246, v186, v187, v246
    v_mfma_f32_16x16x32_bf16 v[188:191], a[192:195], a[176:179], 0
    v_mfma_f32_16x16x32_bf16 v[188:191], a[196:199], a[180:183], v[188:191]
    v_mfma_f32_16x16x32_bf16 v[188:191], a[200:203], a[184:187], v[188:191]
    v_mfma_f32_16x16x32_bf16 v[188:191], a[204:207], a[188:191], v[188:191]
    s_nop 7
    v_max3_f32 v247, v188, v189, v247
    v_max3_f32 v247, v190, v191, v247
    s_barrier
    s_add_u32 s33, s33, 16384
    s_sub_u32 s36, s36, 1
    s_cmp_lg_u32 s36, 0
    s_cbranch_scc1 L_safe_loop
    v_mov_b32 v223, v242
    s_nop 1
    v_permlane32_swap_b32 v242, v223
    v_max_f32 v242, v242, v223
    v_mov_b32 v223, v242
    s_nop 1
    v_permlane16_swap_b32 v242, v223
    v_max_f32 v242, v242, v223
    v_sub_f32 v112, 0, v242
    v_sub_f32 v113, 0, v242
    v_sub_f32 v114, 0, v242
    v_sub_f32 v115, 0, v242
    v_mov_b32 v192, 0
    v_mov_b32 v223, v243
    s_nop 1
    v_permlane32_swap_b32 v243, v223
    v_max_f32 v243, v243, v223
    v_mov_b32 v223, v243
    s_nop 1
    v_permlane16_swap_b32 v243, v223
    v_max_f32 v243, v243, v223
    v_sub_f32 v116, 0, v243
    v_sub_f32 v117, 0, v243
    v_sub_f32 v118, 0, v243
    v_sub_f32 v119, 0, v243
    v_mov_b32 v193, 0
    v_mov_b32 v223, v244
    s_nop 1
    v_permlane32_swap_b32 v244, v223
    v_max_f32 v244, v244, v223
    v_mov_b32 v223, v244
    s_nop 1
    v_permlane16_swap_b32 v244, v223
    v_max_f32 v244, v244, v223
    v_sub_f32 v120, 0, v244
    v_sub_f32 v121, 0, v244
    v_sub_f32 v122, 0, v244
    v_sub_f32 v123, 0, v244
    v_mov_b32 v194, 0
    v_mov_b32 v223, v245
    s_nop 1
    v_permlane32_swap_b32 v245, v223
    v_max_f32 v245, v245, v223
    v_mov_b32 v223, v245
    s_nop 1
    v_permlane16_swap_b32 v245, v223
    v_max_f32 v245, v245, v223
    v_sub_f32 v124, 0, v245
    v_sub_f32 v125, 0, v245
    v_sub_f32 v126, 0, v245
    v_sub_f32 v127, 0, v245
    v_mov_b32 v195, 0
    v_mov_b32 v223, v246
    s_nop 1
    v_permlane32_swap_b32 v246, v223
    v_max_f32 v246, v246, v223
    v_mov_b32 v223, v246
    s_nop 1
    v_permlane16_swap_b32 v246, v223
    v_max_f32 v246, v246, v223
    v_sub_f32 v128, 0, v246
    v_sub_f32 v129, 0, v246
    v_sub_f32 v130, 0, v246
    v_sub_f32 v131, 0, v246
    v_mov_b32 v196, 0
    v_mov_b32 v223, v247
    s_nop 1
    v_permlane32_swap_b32 v247, v223
    v_max_f32 v247, v247, v223
    v_mov_b32 v223, v247
    s_nop 1
    v_permlane16_swap_b32 v247, v223
    v_max_f32 v247, v247, v223
    v_sub_f32 v132, 0, v247
    v_sub_f32 v133, 0, v247
    v_sub_f32 v134, 0, v247
    v_sub_f32 v135, 0, v247
    v_mov_b32 v197, 0
    s_add_u32 m0, s76, 53248
    s_nop 0
    buffer_load_dwordx4 v250, s[16:19], s76 offen nt lds
    buffer_load_dwordx4 v251, s[16:19], s76 offen offset:1024 nt lds
    buffer_load_dwordx4 v252, s[16:19], s76 offen offset:2048 nt lds
    s_mov_b32 m0, s77
    s_nop 0
    buffer_load_dwordx4 v253, s[20:23], s77 offen nt lds
    buffer_load_dwordx4 v254, s[20:23], s77 offen offset:1024 nt lds
    s_add_u32 m0, s77, 65536
    s_nop 0
    buffer_load_dwordx4 v214, s[24:27], s77 offen nt lds
    buffer_load_dwordx4 v215, s[24:27], s77 offen offset:1024 nt lds
    s_add_u32 s47, s77, 8192
    s_mov_b32 m0, s47
    s_nop 0
    buffer_load_dwordx4 v253, s[20:23], s47 offen nt lds
    buffer_load_dwordx4 v254, s[20:23], s47 offen offset:1024 nt lds
    s_add_u32 m0, s47, 65536
    s_nop 0
    buffer_load_dwordx4 v214, s[24:27], s47 offen nt lds
    buffer_load_dwordx4 v215, s[24:27], s47 offen offset:1024 nt lds
    s_add_u32 s33, s34, 16384
    s_add_u32 s80, s20, s33
    s_addc_u32 s81, s21, 0
    s_sub_u32 s82, 512000, s33
    s_mov_b32 s83, 0x20000
    s_add_u32 s84, s24, s33
    s_addc_u32 s85, s25, 0
    s_sub_u32 s86, 524288, s33
    s_mov_b32 s87, 0x20000
    s_add_u32 m0, s34, 16384
    s_nop 0
    buffer_load_dwordx4 v210, s[80:83], 0 offen nt lds
    buffer_load_dwordx4 v211, s[80:83], 0 offen offset:1024 nt lds
    buffer_load_dwordx4 v212, s[80:83], 0 offen offset:2048 nt lds
    buffer_load_dwordx4 v213, s[80:83], 0 offen offset:3072 nt lds
    s_add_u32 s80, s80, 16384
    s_addc_u32 s81, s81, 0
    s_sub_i32 s82, s82, 16384
    s_max_i32 s82, s82, 0
    s_add_u32 m0, s35, 16384
    s_nop 0
    buffer_load_dwordx4 v214, s[84:87], 0 offen nt lds
    buffer_load_dwordx4 v215, s[84:87], 0 offen offset:1024 nt lds
    buffer_load_dwordx4 v214, s[84:87], 0 offen offset:2048 nt lds
    buffer_load_dwordx4 v215, s[84:87], 0 offen offset:3072 nt lds
    s_add_u32 s84, s84, 16384
    s_addc_u32 s85, s85, 0
    s_sub_i32 s86, s86, 16384
    s_max_i32 s86, s86, 0
    s_waitcnt vmcnt(16)
    s_barrier
    ds_read_b128 a[240:243], v198 offset:53248
    ds_read_b128 a[244:247], v199 offset:53248
    ds_read_b128 a[248:251], v200 offset:53248
    ds_read_b128 a[252:255], v201 offset:53248
    ds_read_b128 a[208:211], v198 offset:57344
    ds_read_b128 a[212:215], v199 offset:57344
    ds_read_b128 a[216:219], v200 offset:57344
    ds_read_b128 a[220:223], v201 offset:57344
    ds_read_b128 a[192:195], v198 offset:61440
    ds_read_b128 a[196:199], v199 offset:61440
    ds_read_b128 a[200:203], v200 offset:61440
    ds_read_b128 a[204:207], v201 offset:61440
    s_waitcnt lgkmcnt(0)
    v_mfma_f32_16x16x32_bf16 v[184:187], a[240:243], a[96:99], v[112:115]
    v_mfma_f32_16x16x32_bf16 v[184:187], a[244:247], a[100:103], v[184:187]
    v_mfma_f32_16x16x32_bf16 v[184:187], a[248:251], a[104:107], v[184:187]
    v_mfma_f32_16x16x32_bf16 v[184:187], a[252:255], a[108:111], v[184:187]
    v_mfma_f32_16x16x32_bf16 v[188:191], a[208:211], a[96:99], v[112:115]
    v_mfma_f32_16x16x32_bf16 v[188:191], a[212:215], a[100:103], v[188:191]
    v_mfma_f32_16x16x32_bf16 v[188:191], a[216:219], a[104:107], v[188:191]
    v_mfma_f32_16x16x32_bf16 v[188:191], a[220:223], a[108:111], v[188:191]
    s_nop 3
    v_exp_f32 v184, v184
    v_exp_f32 v185, v185
    v_exp_f32 v186, v186
    v_exp_f32 v187, v187
    v_add_f32 v192, v192, v184
    v_add_f32 v192, v192, v185
    v_add_f32 v192, v192, v186
    v_add_f32 v192, v192, v187
    v_cvt_pk_bf16_f32 v136, v184, v185
    v_cvt_pk_bf16_f32 v137, v186, v187
    v_exp_f32 v188, v188
    v_exp_f32 v189, v189
    v_exp_f32 v190, v190
    v_exp_f32 v191, v191
    v_add_f32 v192, v192, v188
    v_add_f32 v192, v192, v189
    v_add_f32 v192, v192, v190
    v_add_f32 v192, v192, v191
    v_cvt_pk_bf16_f32 v138, v188, v189
    v_cvt_pk_bf16_f32 v139, v190, v191
    v_mfma_f32_16x16x32_bf16 v[184:187], a[240:243], a[112:115], v[116:119]
    v_mfma_f32_16x16x32_bf16 v[184:187], a[244:247], a[116:119], v[184:187]
    v_mfma_f32_16x16x32_bf16 v[184:187], a[248:251], a[120:123], v[184:187]
    v_mfma_f32_16x16x32_bf16 v[184:187], a[252:255], a[124:127], v[184:187]
    v_mfma_f32_16x16x32_bf16 v[188:191], a[208:211], a[112:115], v[116:119]
    v_mfma_f32_16x16x32_bf16 v[188:191], a[212:215], a[116:119], v[188:191]
    v_mfma_f32_16x16x32_bf16 v[188:191], a[216:219], a[120:123], v[188:191]
    v_mfma_f32_16x16x32_bf16 v[188:191], a[220:223], a[124:127], v[188:191]
    s_nop 3
    v_exp_f32 v184, v184
    v_exp_f32 v185, v185
    v_exp_f32 v186, v186
    v_exp_f32 v187, v187
    v_add_f32 v193, v193, v184
    v_add_f32 v193, v193, v185
    v_add_f32 v193, v193, v186
    v_add_f32 v193, v193, v187
    v_cvt_pk_bf16_f32 v140, v184, v185
    v_cvt_pk_bf16_f32 v141, v186, v187
    v_exp_f32 v188, v188
    v_exp_f32 v189, v189
    v_exp_f32 v190, v190
    v_exp_f32 v191, v191
    v_add_f32 v193, v193, v188
    v_add_f32 v193, v193, v189
    v_add_f32 v193, v193, v190
    v_add_f32 v193, v193, v191
    v_cvt_pk_bf16_f32 v142, v188, v189
    v_cvt_pk_bf16_f32 v143, v190, v191
    v_mfma_f32_16x16x32_bf16 v[184:187], a[240:243], a[128:131], v[120:123]
    v_mfma_f32_16x16x32_bf16 v[184:187], a[244:247], a[132:135], v[184:187]
    v_mfma_f32_16x16x32_bf16 v[184:187], a[248:251], a[136:139], v[184:187]
    v_mfma_f32_16x16x32_bf16 v[184:187], a[252:255], a[140:143], v[184:187]
    v_mfma_f32_16x16x32_bf16 v[188:191], a[208:211], a[128:131], v[120:123]
    v_mfma_f32_16x16x32_bf16 v[188:191], a[212:215], a[132:135], v[188:191]
    v_mfma_f32_16x16x32_bf16 v[188:191], a[216:219], a[136:139], v[188:191]
    v_mfma_f32_16x16x32_bf16 v[188:191], a[220:223], a[140:143], v[188:191]
    s_nop 3
    v_exp_f32 v184, v184
    v_exp_f32 v185, v185
    v_exp_f32 v186, v186
    v_exp_f32 v187, v187
    v_add_f32 v194, v194, v184
    v_add_f32 v194, v194, v185
    v_add_f32 v194, v194, v186
    v_add_f32 v194, v194, v187
    v_cvt_pk_bf16_f32 v144, v184, v185
    v_cvt_pk_bf16_f32 v145, v186, v187
    v_exp_f32 v188, v188
    v_exp_f32 v189, v189
    v_exp_f32 v190, v190
    v_exp_f32 v191, v191
    v_add_f32 v194, v194, v188
    v_add_f32 v194, v194, v189
    v_add_f32 v194, v194, v190
    v_add_f32 v194, v194, v191
    v_cvt_pk_bf16_f32 v146, v188, v189
    v_cvt_pk_bf16_f32 v147, v190, v191
    v_mfma_f32_16x16x32_bf16 v[184:187], a[240:243], a[144:147], v[124:127]
    v_mfma_f32_16x16x32_bf16 v[184:187], a[244:247], a[148:151], v[184:187]
    v_mfma_f32_16x16x32_bf16 v[184:187], a[248:251], a[152:155], v[184:187]
    v_mfma_f32_16x16x32_bf16 v[184:187], a[252:255], a[156:159], v[184:187]
    v_mfma_f32_16x16x32_bf16 v[188:191], a[208:211], a[144:147], v[124:127]
    v_mfma_f32_16x16x32_bf16 v[188:191], a[212:215], a[148:151], v[188:191]
    v_mfma_f32_16x16x32_bf16 v[188:191], a[216:219], a[152:155], v[188:191]
    v_mfma_f32_16x16x32_bf16 v[188:191], a[220:223], a[156:159], v[188:191]
    s_nop 3
    v_exp_f32 v184, v184
    v_exp_f32 v185, v185
    v_exp_f32 v186, v186
    v_exp_f32 v187, v187
    v_add_f32 v195, v195, v184
    v_add_f32 v195, v195, v185
    v_add_f32 v195, v195, v186
    v_add_f32 v195, v195, v187
    v_cvt_pk_bf16_f32 v148, v184, v185
    v_cvt_pk_bf16_f32 v149, v186, v187
    v_exp_f32 v188, v188
    v_exp_f32 v189, v189
    v_exp_f32 v190, v190
    v_exp_f32 v191, v191
    v_add_f32 v195, v195, v188
    v_add_f32 v195, v195, v189
    v_add_f32 v195, v195, v190
    v_add_f32 v195, v195, v191
    v_cvt_pk_bf16_f32 v150, v188, v189
    v_cvt_pk_bf16_f32 v151, v190, v191
    v_mfma_f32_16x16x32_bf16 v[184:187], a[240:243], a[160:163], v[128:131]
    v_mfma_f32_16x16x32_bf16 v[184:187], a[244:247], a[164:167], v[184:187]
    v_mfma_f32_16x16x32_bf16 v[184:187], a[248:251], a[168:171], v[184:187]
    v_mfma_f32_16x16x32_bf16 v[184:187], a[252:255], a[172:175], v[184:187]
    v_mfma_f32_16x16x32_bf16 v[188:191], a[208:211], a[160:163], v[128:131]
    v_mfma_f32_16x16x32_bf16 v[188:191], a[212:215], a[164:167], v[188:191]
    v_mfma_f32_16x16x32_bf16 v[188:191], a[216:219], a[168:171], v[188:191]
    v_mfma_f32_16x16x32_bf16 v[188:191], a[220:223], a[172:175], v[188:191]
    s_nop 3
    v_exp_f32 v184, v184
    v_exp_f32 v185, v185
    v_exp_f32 v186, v186
    v_exp_f32 v187, v187
    v_add_f32 v196, v196, v184
    v_add_f32 v196, v196, v185
    v_add_f32 v196, v196, v186
    v_add_f32 v196, v196, v187
    v_cvt_pk_bf16_f32 v152, v184, v185
    v_cvt_pk_bf16_f32 v153, v186, v187
    v_exp_f32 v188, v188
    v_exp_f32 v189, v189
    v_exp_f32 v190, v190
    v_exp_f32 v191, v191
    v_add_f32 v196, v196, v188
    v_add_f32 v196, v196, v189
    v_add_f32 v196, v196, v190
    v_add_f32 v196, v196, v191
    v_cvt_pk_bf16_f32 v154, v188, v189
    v_cvt_pk_bf16_f32 v155, v190, v191
    v_mfma_f32_16x16x32_bf16 v[184:187], a[240:243], a[176:179], v[132:135]
    v_mfma_f32_16x16x32_bf16 v[184:187], a[244:247], a[180:183], v[184:187]
    v_mfma_f32_16x16x32_bf16 v[184:187], a[248:251], a[184:187], v[184:187]
    v_mfma_f32_16x16x32_bf16 v[184:187], a[252:255], a[188:191], v[184:187]
    v_mfma_f32_16x16x32_bf16 v[188:191], a[208:211], a[176:179], v[132:135]
    v_mfma_f32_16x16x32_bf16 v[188:191], a[212:215], a[180:183], v[188:191]
    v_mfma_f32_16x16x32_bf16 v[188:191], a[216:219], a[184:187], v[188:191]
    v_mfma_f32_16x16x32_bf16 v[188:191], a[220:223], a[188:191], v[188:191]
    s_nop 3
    v_exp_f32 v184, v184
    v_exp_f32 v185, v185
    v_exp_f32 v186, v186
    v_exp_f32 v187, v187
    v_add_f32 v197, v197, v184
    v_add_f32 v197, v197, v185
    v_add_f32 v197, v197, v186
    v_add_f32 v197, v197, v187
    v_cvt_pk_bf16_f32 v156, v184, v185
    v_cvt_pk_bf16_f32 v157, v186, v187
    v_exp_f32 v188, v188
    v_exp_f32 v189, v189
    v_exp_f32 v190, v190
    v_exp_f32 v191, v191
    v_add_f32 v197, v197, v188
    v_add_f32 v197, v197, v189
    v_add_f32 v197, v197, v190
    v_add_f32 v197, v197, v191
    v_cvt_pk_bf16_f32 v158, v188, v189
    v_cvt_pk_bf16_f32 v159, v190, v191
    s_mov_b32 s37, 1
    s_branch L_main_entry
L_code_end:
.section .rodata,"a"
.p2align 6
.amdhsa_kernel standalone__mha_softmax__near_ridge_kernel
  .amdhsa_next_free_vgpr 512
  .amdhsa_next_free_sgpr 96
  .amdhsa_accum_offset 256
  .amdhsa_group_segment_fixed_size 0
  .amdhsa_kernarg_size 48
  .amdhsa_user_sgpr_count 2
  .amdhsa_user_sgpr_kernarg_segment_ptr 1
  .amdhsa_system_sgpr_workgroup_id_x 1
.end_amdhsa_kernel
```
